```python
import torch

def _softmax(x, axis=-1):
    return torch.softmax(x, dim=axis)
def _gelu(x):
    return torch.nn.functional.gelu(x, approximate="tanh")
def _silu(x):
    return torch.nn.functional.silu(x)
def _sigmoid(x):
    return torch.sigmoid(x)
def _layernorm(x, axis=-1, eps=1e-5):
    m = x.mean(dim=axis, keepdim=True)
    v = x.var(dim=axis, keepdim=True, unbiased=False)
    return (x - m) / torch.sqrt(v + eps)
def _scatter_add(tgt, idx, src, axis=0):
    return tgt.clone().index_add_(axis, idx, src)
def _segment_sum(src, seg, n):
    out = torch.zeros((n,) + src.shape[1:], dtype=src.dtype)
    return out.index_add_(0, seg, src)
def _pad(x, pw):
    flat = tuple(v for pair in reversed(pw) for v in pair)
    return torch.nn.functional.pad(x, flat)

kernel_name = 'concat_heads__mha_block__sliding_local_dilated__prompt'

def setup_inputs():

    _w = (lambda a: (lambda t: t.to(torch.bfloat16) if t.is_floating_point() else t)(torch.as_tensor(a)))
    def _A_setup():
        B, S, D, H = 1, 2048, 1024, 32
        return {
            "x": _w((lambda *s: torch.randn(*s, dtype=torch.bfloat16) * 0.1)(B, S, D)),
            "wqkv": _w((lambda *s: torch.randn(*s, dtype=torch.bfloat16) * 0.4)(D, 3 * D)),
            "wo": _w((lambda *s: torch.randn(*s, dtype=torch.bfloat16) * 0.8)(D, D)),
        }
    _A_in = _A_setup()

    def _B_setup():
        B, S, D = 1, 2048, 1024
        return {
            "x": _w((lambda *s: torch.randn(*s, dtype=torch.bfloat16) * 0.1)(B, S, D)),
            "wqkv": _w((lambda *s: torch.randn(*s, dtype=torch.bfloat16) * 0.4)(D, 3 * D)),
            "wo": _w((lambda *s: torch.randn(*s, dtype=torch.bfloat16) * 0.8)(D, D)),
        }
    _B_in = _B_setup()

    return {
        "A_x": _A_in["x"],
        "A_wqkv": _A_in["wqkv"],
        "A_wo": _A_in["wo"],
        "B_x": _B_in["x"],
        "B_wqkv": _B_in["wqkv"],
        "B_wo": _B_in["wo"],
    }

def reference(A_x, A_wqkv, A_wo, B_x, B_wqkv, B_wo):
    def _A_ref(x, wqkv, wo):
        B, S, D = x.shape
        H = 32
        Dh = D // H
        qkv = (lambda x, *d: x.permute(*d))((x @ wqkv).reshape(B, S, 3, H, Dh), 2, 0, 3, 1, 4)
        q, k, v = qkv[0], qkv[1], qkv[2]
        scores = torch.einsum("bhqd,bhkd->bhqk", q, k) * (Dh ** -0.5)
        p = _softmax(scores, axis=-1)
        o = torch.einsum("bhqk,bhkd->bhqd", p, v)
        return (lambda x, *d: x.permute(*d))(o, 0, 2, 1, 3).reshape(B, S, D) @ wo

    def _B_ref(x, wqkv, wo):
        B, S, D = x.shape
        H = 32; Dh = D // H
        W, dil = 8, 2
        qkv = (lambda x, *d: x.permute(*d))((x @ wqkv).reshape(B, S, 3, H, Dh), 2, 0, 3, 1, 4)
        q, k, v = qkv[0], qkv[1], qkv[2]
        scale = Dh ** -0.5
        pos = torch.arange(S)
        off = torch.arange(W) * dil
        idx = pos[:, None] - off[None, :]
        mask = idx >= 0
        idx_c = torch.where(mask, idx, 0).reshape(-1)
        kg = k[:, :, idx_c, :].reshape(B, H, S, W, Dh)
        vg = v[:, :, idx_c, :].reshape(B, H, S, W, Dh)
        logits = torch.einsum("bhsd,bhswd->bhsw", q, kg) * scale
        logits = torch.where(mask[None, None, :, :], logits, -1e9)
        attn = _softmax(logits, axis=-1)
        o = torch.einsum("bhsw,bhswd->bhsd", attn, vg)
        return (lambda x, *d: x.permute(*d))(o, 0, 2, 1, 3).reshape(B, S, D) @ wo

    a = _A_ref(A_x, A_wqkv, A_wo)
    b = _B_ref(B_x, B_wqkv, B_wo)
    return torch.concatenate([a, b], axis=-1)
```

```asm
; @launch kernel=concat_heads__mha_block__sliding_local_dilated__prompt_kernel grid=(256,1,1) block=(512,1,1) lds=163840
.amdgcn_target "amdgcn-amd-amdhsa--gfx950"
.text
.globl concat_heads__mha_block__sliding_local_dilated__prompt_kernel
.p2align 8
.type concat_heads__mha_block__sliding_local_dilated__prompt_kernel,@function
concat_heads__mha_block__sliding_local_dilated__prompt_kernel:
    s_cmp_ge_u32 s2, 256
    s_cbranch_scc1 L2_end
    s_and_b32 s20, s2, 7
    s_lshr_b32 s21, s2, 3
    s_lshr_b32 s22, s21, 4
    s_mul_i32 s23, s22, 24
    s_load_dwordx4 s[4:7], s[0:1], s23
    s_load_dwordx4 s[96:99], s[0:1], 56
    s_load_dwordx4 s[88:91], s[0:1], 0
    v_lshrrev_b32 v1, 6, v0
    v_and_b32 v0, 63, v0
    v_readfirstlane_b32 s26, v1
    s_and_b32 s24, s20, 1
    s_lshl_b32 s24, s24, 2
    s_and_b32 s25, s21, 3
    s_add_u32 s24, s24, s25
    s_lshr_b32 s25, s20, 1
    s_lshl_b32 s25, s25, 1
    s_lshr_b32 s25, 0xd8, s25
    s_and_b32 s25, s25, 3
    s_mov_b32 s36, s25
    s_xor_b32 s53, s25, s22
    s_lshl_b32 s25, s53, 2
    s_bfe_u32 s27, s21, 0x20002
    s_add_u32 s25, s25, s27
    s_and_b32 s31, s26, 3
    s_lshr_b32 s32, s26, 2
    s_lshl_b32 s45, s20, 2
    s_lshr_b32 s54, 0x7ef65cd4, s45
    s_and_b32 s54, s54, 15
    s_mov_b32 s44, s54
    v_lshrrev_b32 v2, 3, v0
    v_and_b32 v3, 7, v0
    v_lshrrev_b32 v4, 4, v0
    s_cmp_lg_u32 s32, 0
    s_cbranch_scc1 L1_W
    v_lshlrev_b32 v5, 11, v2
    v_xor_b32 v6, v3, v4
    v_lshl_add_u32 v6, v6, 4, v5
    v_xor_b32 v7, 64, v6
    v_mov_b32 v10, v6
    v_add_u32 v11, 16384, v7
    v_add_u32 v12, 32768, v6
    v_add_u32 v13, 49152, v7
    s_lshl_b32 s27, s24, 19
    s_lshl_b32 s28, s31, 16
    s_add_u32 s45, s27, s28
    s_lshl_b32 s46, s44, 7
    s_add_u32 s27, s45, s46
    s_add_u32 s28, s27, 0x40000
    s_lshl_b32 s29, s31, 12
    s_add_u32 s30, s29, 98304
    s_waitcnt lgkmcnt(0)
    s_mov_b32 s8, s4
    s_mov_b32 s9, s5
    s_mov_b32 s10, 0x400000
    s_mov_b32 s11, 0x00020000
    s_add_u32 m0, s29, 0
    s_nop 0
    buffer_load_dwordx4 v10, s[8:11], s27 offen lds
    s_add_u32 m0, s29, 1024
    s_nop 0
    buffer_load_dwordx4 v11, s[8:11], s27 offen lds
    s_add_u32 m0, s29, 2048
    s_nop 0
    buffer_load_dwordx4 v12, s[8:11], s27 offen lds
    s_add_u32 m0, s29, 3072
    s_nop 0
    buffer_load_dwordx4 v13, s[8:11], s27 offen lds
    s_add_u32 s29, s29, 16384
    s_add_u32 s46, s46, 128
    s_and_b32 s46, s46, 0x7ff
    s_add_u32 s27, s45, s46
    s_add_u32 m0, s29, 0
    s_nop 0
    buffer_load_dwordx4 v10, s[8:11], s28 offen lds
    s_add_u32 m0, s29, 1024
    s_nop 0
    buffer_load_dwordx4 v11, s[8:11], s28 offen lds
    s_add_u32 m0, s29, 2048
    s_nop 0
    buffer_load_dwordx4 v12, s[8:11], s28 offen lds
    s_add_u32 m0, s29, 3072
    s_nop 0
    buffer_load_dwordx4 v13, s[8:11], s28 offen lds
    s_add_u32 s29, s29, 16384
    s_add_u32 s28, s27, 0x40000
    s_cmp_eq_u32 s29, s30
    s_cselect_b32 s38, 98304, 0
    s_sub_u32 s29, s29, s38
    s_mov_b32 s16, s98
    s_mov_b32 s17, s99
    s_mov_b32 s18, 0x2100000
    s_mov_b32 s19, 0x00020000
    v_and_b32 v2, 15, v0
    v_lshrrev_b32 v3, 4, v0
    v_bfe_u32 v4, v0, 1, 3
    s_lshl_b32 s33, s31, 13
    v_lshlrev_b32 v5, 7, v2
    v_add_u32 v5, s33, v5
    v_xor_b32 v6, v3, v4
    v_lshl_add_u32 v18, v6, 4, v5
    v_xor_b32 v19, 64, v18
    v_mov_b32 v20, v18
    v_mov_b32 v21, v19
    v_bfe_u32 v4, v0, 2, 2
    v_lshl_add_u32 v4, v3, 3, v4
    v_lshlrev_b32 v4, 7, v4
    v_and_b32 v6, 3, v0
    v_lshl_add_u32 v4, v6, 3, v4
    v_bfe_u32 v5, v0, 3, 2
    s_lshl_b32 s33, s32, 1
    v_xor_b32 v5, s33, v5
    v_lshl_add_u32 v22, v5, 5, v4
    v_xor_b32 v23, 32, v22
    v_add_u32 v24, 98304, v22
    v_add_u32 v25, 98304, v23
    v_lshlrev_b32 v4, 4, v2
    v_lshl_add_u32 v26, v3, 9, v4
    v_mov_b32 v112, 0
    v_mov_b32 v113, 0
    v_mov_b32 v114, 0
    v_mov_b32 v115, 0
    v_mov_b32 v116, 0
    v_mov_b32 v117, 0
    v_mov_b32 v118, 0
    v_mov_b32 v119, 0
    v_mov_b32 v120, 0
    v_mov_b32 v121, 0
    v_mov_b32 v122, 0
    v_mov_b32 v123, 0
    v_mov_b32 v124, 0
    v_mov_b32 v125, 0
    v_mov_b32 v126, 0
    v_mov_b32 v127, 0
    v_mov_b32 v128, 0
    v_mov_b32 v129, 0
    v_mov_b32 v130, 0
    v_mov_b32 v131, 0
    v_mov_b32 v132, 0
    v_mov_b32 v133, 0
    v_mov_b32 v134, 0
    v_mov_b32 v135, 0
    v_mov_b32 v136, 0
    v_mov_b32 v137, 0
    v_mov_b32 v138, 0
    v_mov_b32 v139, 0
    v_mov_b32 v140, 0
    v_mov_b32 v141, 0
    v_mov_b32 v142, 0
    v_mov_b32 v143, 0
    v_mov_b32 v144, 0
    v_mov_b32 v145, 0
    v_mov_b32 v146, 0
    v_mov_b32 v147, 0
    v_mov_b32 v148, 0
    v_mov_b32 v149, 0
    v_mov_b32 v150, 0
    v_mov_b32 v151, 0
    v_mov_b32 v152, 0
    v_mov_b32 v153, 0
    v_mov_b32 v154, 0
    v_mov_b32 v155, 0
    v_mov_b32 v156, 0
    v_mov_b32 v157, 0
    v_mov_b32 v158, 0
    v_mov_b32 v159, 0
    v_mov_b32 v160, 0
    v_mov_b32 v161, 0
    v_mov_b32 v162, 0
    v_mov_b32 v163, 0
    v_mov_b32 v164, 0
    v_mov_b32 v165, 0
    v_mov_b32 v166, 0
    v_mov_b32 v167, 0
    v_mov_b32 v168, 0
    v_mov_b32 v169, 0
    v_mov_b32 v170, 0
    v_mov_b32 v171, 0
    v_mov_b32 v172, 0
    v_mov_b32 v173, 0
    v_mov_b32 v174, 0
    v_mov_b32 v175, 0
    v_mov_b32 v176, 0
    v_mov_b32 v177, 0
    v_mov_b32 v178, 0
    v_mov_b32 v179, 0
    v_mov_b32 v180, 0
    v_mov_b32 v181, 0
    v_mov_b32 v182, 0
    v_mov_b32 v183, 0
    v_mov_b32 v184, 0
    v_mov_b32 v185, 0
    v_mov_b32 v186, 0
    v_mov_b32 v187, 0
    v_mov_b32 v188, 0
    v_mov_b32 v189, 0
    v_mov_b32 v190, 0
    v_mov_b32 v191, 0
    v_mov_b32 v192, 0
    v_mov_b32 v193, 0
    v_mov_b32 v194, 0
    v_mov_b32 v195, 0
    v_mov_b32 v196, 0
    v_mov_b32 v197, 0
    v_mov_b32 v198, 0
    v_mov_b32 v199, 0
    v_mov_b32 v200, 0
    v_mov_b32 v201, 0
    v_mov_b32 v202, 0
    v_mov_b32 v203, 0
    v_mov_b32 v204, 0
    v_mov_b32 v205, 0
    v_mov_b32 v206, 0
    v_mov_b32 v207, 0
    s_lshl_b32 s40, s22, 22
    s_lshl_b32 s41, s25, 1
    s_add_u32 s41, s41, s32
    s_lshl_b32 s41, s41, 17
    s_add_u32 s40, s40, s41
    s_lshl_b32 s41, s24, 14
    s_add_u32 s40, s40, s41
    s_lshl_b32 s41, s31, 12
    s_add_u32 s40, s40, s41
    s_add_u32 s41, s40, 8388608
    s_add_u32 s42, s40, 16777216
    s_mov_b32 s43, 0x3e8293ee
    s_lshl_b32 s95, s25, 3
    s_add_u32 s95, s95, s24
    s_lshl_b32 s94, s95, 2
    s_add_u32 s94, s94, s31
    s_add_u32 s94, s94, 1408
    s_add_u32 s95, s95, 1280
    s_cmp_eq_u32 s22, 0
    s_cselect_b32 s95, s95, s94
    s_lshl_b32 s95, s95, 5
    s_add_u32 s95, s95, 33554432
    s_mov_b32 s80, s96
    s_mov_b32 s81, s97
    s_mov_b32 s82, 0x100
    s_mov_b32 s83, 0x00020000
    s_mov_b32 s33, 0
    s_mov_b32 s34, 98304
    s_mov_b32 s35, 0
    s_lshl_b32 s47, s20, 2
    s_lshr_b32 s48, s21, 3
    s_add_u32 s47, s47, s48
    s_and_b32 s48, s21, 7
    s_lshl_b32 s49, s48, 5
    s_add_u32 s49, s49, s47
    s_lshl_b32 s49, s49, 5
    s_add_u32 s49, s49, 33554432
    s_lshl_b32 s50, s48, 7
    s_add_u32 s50, s50, s47
    s_add_u32 s50, s50, 256
    s_lshl_b32 s50, s50, 5
    s_add_u32 s50, s50, 33554432
    v_and_b32 v9, 3, v0
    v_lshlrev_b32 v8, 10, v9
    v_add_u32 v8, s50, v8
    s_lshl_b32 s48, s22, 5
    v_mul_u32_u24 v9, s48, v9
    v_add_u32 v9, s95, v9
    s_mov_b64 s[50:51], 0xf00
    v_cndmask_b32 v8, v8, v9, s[50:51]
    v_mov_b32 v9, s49
    s_mov_b64 s[50:51], 1
    v_cndmask_b32 v8, v8, v9, s[50:51]
    v_mov_b32 v9, 0
    s_cmp_eq_u32 s31, 0
    s_cselect_b64 exec, 0xff1, 0
    s_cbranch_execz L1_nofl
    buffer_store_dword v9, v8, s[16:19], 0 offen sc1
L1_nofl:
    s_mov_b64 exec, -1
    s_add_u32 m0, s29, 0
    s_nop 0
    buffer_load_dwordx4 v10, s[8:11], s27 offen lds
    s_add_u32 m0, s29, 1024
    s_nop 0
    buffer_load_dwordx4 v11, s[8:11], s27 offen lds
    s_add_u32 m0, s29, 2048
    s_nop 0
    buffer_load_dwordx4 v12, s[8:11], s27 offen lds
    s_add_u32 m0, s29, 3072
    s_nop 0
    buffer_load_dwordx4 v13, s[8:11], s27 offen lds
    s_add_u32 s29, s29, 16384
    s_add_u32 s46, s46, 128
    s_and_b32 s46, s46, 0x7ff
    s_add_u32 s27, s45, s46
    s_add_u32 m0, s29, 0
    s_nop 0
    buffer_load_dwordx4 v10, s[8:11], s28 offen lds
    s_add_u32 m0, s29, 1024
    s_nop 0
    buffer_load_dwordx4 v11, s[8:11], s28 offen lds
    s_add_u32 m0, s29, 2048
    s_nop 0
    buffer_load_dwordx4 v12, s[8:11], s28 offen lds
    s_add_u32 m0, s29, 3072
    s_nop 0
    buffer_load_dwordx4 v13, s[8:11], s28 offen lds
    s_add_u32 s29, s29, 16384
    s_add_u32 s28, s27, 0x40000
    s_cmp_eq_u32 s29, s30
    s_cselect_b32 s38, 98304, 0
    s_sub_u32 s29, s29, s38
    s_waitcnt vmcnt(8)
    s_barrier
    v_mov_b32 v8, 1
    s_lshr_b32 s47, s2, 5
    s_lshl_b32 s47, s47, 1
    s_add_u32 s47, s47, 2
    s_cmp_eq_u32 s31, 0
    s_cselect_b32 s47, s47, 0x7fff
    ds_read_b64_tr_b16 v[48:49], v24 offset:0
    ds_read_b64_tr_b16 v[50:51], v24 offset:512
    ds_read_b128 v[32:35], v20 offset:0
    ds_read_b128 v[36:39], v20 offset:2048
    ds_read_b128 v[40:43], v20 offset:4096
    ds_read_b128 v[44:47], v20 offset:6144
    ds_read_b64_tr_b16 v[52:53], v25 offset:0
    ds_read_b64_tr_b16 v[54:55], v25 offset:512
    ds_read_b64_tr_b16 v[56:57], v24 offset:4096
    ds_read_b64_tr_b16 v[58:59], v24 offset:4608
    ds_read_b64_tr_b16 v[60:61], v25 offset:4096
    ds_read_b64_tr_b16 v[62:63], v25 offset:4608
    ds_read_b64_tr_b16 v[64:65], v24 offset:8192
    ds_read_b64_tr_b16 v[66:67], v24 offset:8704
    ds_read_b64_tr_b16 v[68:69], v25 offset:8192
    ds_read_b64_tr_b16 v[70:71], v25 offset:8704
    s_add_u32 m0, s29, 0
    s_nop 0
    buffer_load_dwordx4 v10, s[8:11], s27 offen lds
    s_add_u32 m0, s29, 1024
    s_nop 0
    buffer_load_dwordx4 v11, s[8:11], s27 offen lds
    s_add_u32 m0, s29, 2048
    s_nop 0
    buffer_load_dwordx4 v12, s[8:11], s27 offen lds
    s_add_u32 m0, s29, 3072
    s_nop 0
    buffer_load_dwordx4 v13, s[8:11], s27 offen lds
    s_add_u32 s29, s29, 16384
    s_add_u32 s46, s46, 128
    s_and_b32 s46, s46, 0x7ff
    s_add_u32 s27, s45, s46
    s_add_u32 s34, s34, 12288
    s_cmp_eq_u32 s34, 159744
    s_cselect_b32 s34, 98304, s34
    v_add_u32 v24, s34, v22
    v_add_u32 v25, s34, v23
    s_add_u32 s35, s35, 1
    s_waitcnt lgkmcnt(0)
    s_barrier
    s_branch L1X_odd
.p2align 6
L1X_loop:
    v_mfma_f32_16x16x32_bf16 v[112:115], v[88:91], v[72:75], v[112:115]
    ds_read_b64_tr_b16 v[48:49], v24 offset:0
    s_add_u32 m0, s29, 0
    s_add_u32 s34, s34, 12288
    v_mfma_f32_16x16x32_bf16 v[136:139], v[88:91], v[76:79], v[136:139]
    buffer_load_dwordx4 v10, s[8:11], s27 offen lds
    s_cmp_eq_u32 s34, 159744
    s_cselect_b32 s34, 98304, s34
    v_mfma_f32_16x16x32_bf16 v[160:163], v[88:91], v[80:83], v[160:163]
    ds_read_b64_tr_b16 v[50:51], v24 offset:512
    s_add_u32 s35, s35, 1
    v_mfma_f32_16x16x32_bf16 v[184:187], v[88:91], v[84:87], v[184:187]
    ds_read_b128 v[32:35], v20 offset:0
    v_mfma_f32_16x16x32_bf16 v[116:119], v[92:95], v[72:75], v[116:119]
    ds_read_b128 v[36:39], v20 offset:2048
    s_add_u32 m0, s29, 1024
    v_mfma_f32_16x16x32_bf16 v[140:143], v[92:95], v[76:79], v[140:143]
    buffer_load_dwordx4 v11, s[8:11], s27 offen lds
    v_mfma_f32_16x16x32_bf16 v[164:167], v[92:95], v[80:83], v[164:167]
    ds_read_b128 v[40:43], v20 offset:4096
    v_mfma_f32_16x16x32_bf16 v[188:191], v[92:95], v[84:87], v[188:191]
    ds_read_b128 v[44:47], v20 offset:6144
    v_mfma_f32_16x16x32_bf16 v[120:123], v[96:99], v[72:75], v[120:123]
    ds_read_b64_tr_b16 v[52:53], v25 offset:0
    s_add_u32 m0, s29, 2048
    v_mfma_f32_16x16x32_bf16 v[144:147], v[96:99], v[76:79], v[144:147]
    buffer_load_dwordx4 v12, s[8:11], s27 offen lds
    v_mfma_f32_16x16x32_bf16 v[168:171], v[96:99], v[80:83], v[168:171]
    ds_read_b64_tr_b16 v[54:55], v25 offset:512
    v_mfma_f32_16x16x32_bf16 v[192:195], v[96:99], v[84:87], v[192:195]
    ds_read_b64_tr_b16 v[56:57], v24 offset:4096
    v_mfma_f32_16x16x32_bf16 v[124:127], v[100:103], v[72:75], v[124:127]
    ds_read_b64_tr_b16 v[58:59], v24 offset:4608
    s_add_u32 m0, s29, 3072
    v_mfma_f32_16x16x32_bf16 v[148:151], v[100:103], v[76:79], v[148:151]
    buffer_load_dwordx4 v13, s[8:11], s27 offen lds
    s_add_u32 s29, s29, 16384
    s_add_u32 s46, s46, 128
    v_mfma_f32_16x16x32_bf16 v[172:175], v[100:103], v[80:83], v[172:175]
    ds_read_b64_tr_b16 v[60:61], v25 offset:4096
    s_and_b32 s46, s46, 0x7ff
    s_add_u32 s27, s45, s46
    v_mfma_f32_16x16x32_bf16 v[196:199], v[100:103], v[84:87], v[196:199]
    ds_read_b64_tr_b16 v[62:63], v25 offset:4608
    v_mfma_f32_16x16x32_bf16 v[128:131], v[72:75], v[104:107], v[128:131]
    ds_read_b64_tr_b16 v[64:65], v24 offset:8192
    v_mfma_f32_16x16x32_bf16 v[152:155], v[76:79], v[104:107], v[152:155]
    ds_read_b64_tr_b16 v[66:67], v24 offset:8704
    v_mfma_f32_16x16x32_bf16 v[176:179], v[80:83], v[104:107], v[176:179]
    ds_read_b64_tr_b16 v[68:69], v25 offset:8192
    v_mfma_f32_16x16x32_bf16 v[200:203], v[84:87], v[104:107], v[200:203]
    ds_read_b64_tr_b16 v[70:71], v25 offset:8704
    v_add_u32 v24, s34, v22
    v_add_u32 v25, s34, v23
    v_mfma_f32_16x16x32_bf16 v[132:135], v[72:75], v[108:111], v[132:135]
    v_mfma_f32_16x16x32_bf16 v[156:159], v[76:79], v[108:111], v[156:159]
    v_mfma_f32_16x16x32_bf16 v[180:183], v[80:83], v[108:111], v[180:183]
    v_mfma_f32_16x16x32_bf16 v[204:207], v[84:87], v[108:111], v[204:207]
    s_waitcnt lgkmcnt(0)
    s_barrier
L1X_odd:
    v_mfma_f32_16x16x32_bf16 v[112:115], v[48:51], v[32:35], v[112:115]
    ds_read_b64_tr_b16 v[88:89], v24 offset:0
    s_add_u32 m0, s29, 0
    s_add_u32 s34, s34, 12288
    v_mfma_f32_16x16x32_bf16 v[136:139], v[48:51], v[36:39], v[136:139]
    buffer_load_dwordx4 v10, s[8:11], s28 offen lds
    s_cmp_eq_u32 s34, 159744
    s_cselect_b32 s34, 98304, s34
    v_mfma_f32_16x16x32_bf16 v[160:163], v[48:51], v[40:43], v[160:163]
    ds_read_b64_tr_b16 v[90:91], v24 offset:512
    s_add_u32 s35, s35, 1
    s_add_u32 s33, s33, 32768
    v_mfma_f32_16x16x32_bf16 v[184:187], v[48:51], v[44:47], v[184:187]
    ds_read_b128 v[72:75], v21 offset:0
    s_cmp_eq_u32 s33, 98304
    s_cselect_b32 s33, 0, s33
    v_mfma_f32_16x16x32_bf16 v[116:119], v[52:55], v[32:35], v[116:119]
    ds_read_b128 v[76:79], v21 offset:2048
    s_add_u32 m0, s29, 1024
    v_mfma_f32_16x16x32_bf16 v[140:143], v[52:55], v[36:39], v[140:143]
    buffer_load_dwordx4 v11, s[8:11], s28 offen lds
    v_mfma_f32_16x16x32_bf16 v[164:167], v[52:55], v[40:43], v[164:167]
    ds_read_b128 v[80:83], v21 offset:4096
    v_mfma_f32_16x16x32_bf16 v[188:191], v[52:55], v[44:47], v[188:191]
    ds_read_b128 v[84:87], v21 offset:6144
    v_mfma_f32_16x16x32_bf16 v[120:123], v[56:59], v[32:35], v[120:123]
    ds_read_b64_tr_b16 v[92:93], v25 offset:0
    s_add_u32 m0, s29, 2048
    v_mfma_f32_16x16x32_bf16 v[144:147], v[56:59], v[36:39], v[144:147]
    buffer_load_dwordx4 v12, s[8:11], s28 offen lds
    v_mfma_f32_16x16x32_bf16 v[168:171], v[56:59], v[40:43], v[168:171]
    ds_read_b64_tr_b16 v[94:95], v25 offset:512
    v_mfma_f32_16x16x32_bf16 v[192:195], v[56:59], v[44:47], v[192:195]
    ds_read_b64_tr_b16 v[96:97], v24 offset:4096
    v_mfma_f32_16x16x32_bf16 v[124:127], v[60:63], v[32:35], v[124:127]
    ds_read_b64_tr_b16 v[98:99], v24 offset:4608
    s_add_u32 m0, s29, 3072
    v_mfma_f32_16x16x32_bf16 v[148:151], v[60:63], v[36:39], v[148:151]
    buffer_load_dwordx4 v13, s[8:11], s28 offen lds
    s_add_u32 s29, s29, 16384
    s_add_u32 s28, s27, 0x40000
    v_mfma_f32_16x16x32_bf16 v[172:175], v[60:63], v[40:43], v[172:175]
    ds_read_b64_tr_b16 v[100:101], v25 offset:4096
    s_cmp_eq_u32 s29, s30
    s_cselect_b32 s38, 98304, 0
    v_mfma_f32_16x16x32_bf16 v[196:199], v[60:63], v[44:47], v[196:199]
    ds_read_b64_tr_b16 v[102:103], v25 offset:4608
    s_sub_u32 s29, s29, s38
    v_mfma_f32_16x16x32_bf16 v[128:131], v[32:35], v[64:67], v[128:131]
    ds_read_b64_tr_b16 v[104:105], v24 offset:8192
    v_mfma_f32_16x16x32_bf16 v[152:155], v[36:39], v[64:67], v[152:155]
    ds_read_b64_tr_b16 v[106:107], v24 offset:8704
    v_mfma_f32_16x16x32_bf16 v[176:179], v[40:43], v[64:67], v[176:179]
    ds_read_b64_tr_b16 v[108:109], v25 offset:8192
    v_mfma_f32_16x16x32_bf16 v[200:203], v[44:47], v[64:67], v[200:203]
    ds_read_b64_tr_b16 v[110:111], v25 offset:8704
    v_add_u32 v24, s34, v22
    v_add_u32 v25, s34, v23
    v_mfma_f32_16x16x32_bf16 v[132:135], v[32:35], v[68:71], v[132:135]
    v_add_u32 v20, s33, v18
    v_add_u32 v21, s33, v19
    v_mfma_f32_16x16x32_bf16 v[156:159], v[36:39], v[68:71], v[156:159]
    v_mfma_f32_16x16x32_bf16 v[180:183], v[40:43], v[68:71], v[180:183]
    v_mfma_f32_16x16x32_bf16 v[204:207], v[44:47], v[68:71], v[204:207]
    s_cmp_eq_u32 s35, s47
    s_cbranch_scc1 L1_at
L1_atr:
    s_cmp_lt_u32 s35, 28
    s_waitcnt vmcnt(8) lgkmcnt(0)
    s_barrier
    s_cbranch_scc1 L1X_loop
    s_branch L1_epi
L1_at:
    s_mov_b64 exec, 1
    buffer_atomic_add v8, v9, s[80:83], 0 offen sc1
    s_mov_b64 exec, -1
    s_branch L1_atr
L1_W:
    s_cmp_lg_u32 s26, 7
    s_cbranch_scc1 L1_nocp
    s_getpc_b64 s[56:57]
Lcp1:
    s_add_u32 s56, s56, concat_heads__mha_block__sliding_local_dilated__prompt_kernel-Lcp1
    s_addc_u32 s57, s57, (concat_heads__mha_block__sliding_local_dilated__prompt_kernel-Lcp1)>>32
    v_lshlrev_b32 v29, 7, v0
    v_min_u32 v29, (L1_epi)-(concat_heads__mha_block__sliding_local_dilated__prompt_kernel)-4, v29
    global_load_dword v29, v29, s[56:57]
L1_nocp:
    v_mul_u32_u24 v5, 6144, v2
    v_and_b32 v6, 1, v4
    v_lshlrev_b32 v6, 1, v6
    s_and_b32 s33, s26, 1
    s_lshl_b32 s33, s33, 2
    v_xor_b32 v6, v3, v6
    v_xor_b32 v6, s33, v6
    v_lshl_add_u32 v10, v6, 4, v5
    v_add_u32 v11, 2048, v10
    v_add_u32 v12, 4096, v10
    s_lshl_b32 s27, s25, 7
    s_mul_i32 s28, s31, 49152
    s_add_u32 s27, s27, s28
    s_mul_i32 s28, s44, 393216
    s_add_u32 s27, s27, s28
    s_lshl_b32 s29, s31, 10
    s_add_u32 s29, s29, 98304
    s_add_u32 s30, s29, 61440
    s_waitcnt lgkmcnt(0)
    s_mov_b32 s12, s6
    s_mov_b32 s13, s7
    s_mov_b32 s14, 0x600000
    s_mov_b32 s15, 0x00020000
    s_add_u32 m0, s29, 0
    s_nop 0
    buffer_load_dwordx4 v10, s[12:15], s27 offen lds
    s_add_u32 m0, s29, 4096
    s_nop 0
    buffer_load_dwordx4 v11, s[12:15], s27 offen lds
    s_add_u32 m0, s29, 8192
    s_nop 0
    buffer_load_dwordx4 v12, s[12:15], s27 offen lds
    s_add_u32 s27, s27, 196608
    s_add_u32 s29, s29, 12288
    s_cmp_eq_u32 s29, s30
    s_cselect_b32 s38, 61440, 0
    s_sub_u32 s29, s29, s38
    s_mov_b32 s16, s98
    s_mov_b32 s17, s99
    s_mov_b32 s18, 0x2100000
    s_mov_b32 s19, 0x00020000
    v_and_b32 v2, 15, v0
    v_lshrrev_b32 v3, 4, v0
    v_bfe_u32 v4, v0, 1, 3
    s_lshl_b32 s33, s31, 13
    v_lshlrev_b32 v5, 7, v2
    v_add_u32 v5, s33, v5
    v_xor_b32 v6, v3, v4
    v_lshl_add_u32 v18, v6, 4, v5
    v_xor_b32 v19, 64, v18
    v_mov_b32 v20, v18
    v_mov_b32 v21, v19
    v_bfe_u32 v4, v0, 2, 2
    v_lshl_add_u32 v4, v3, 3, v4
    v_lshlrev_b32 v4, 7, v4
    v_and_b32 v6, 3, v0
    v_lshl_add_u32 v4, v6, 3, v4
    v_bfe_u32 v5, v0, 3, 2
    s_lshl_b32 s33, s32, 1
    v_xor_b32 v5, s33, v5
    v_lshl_add_u32 v22, v5, 5, v4
    v_xor_b32 v23, 32, v22
    v_add_u32 v24, 98304, v22
    v_add_u32 v25, 98304, v23
    v_lshlrev_b32 v4, 4, v2
    v_lshl_add_u32 v26, v3, 9, v4
    v_mov_b32 v112, 0
    v_mov_b32 v113, 0
    v_mov_b32 v114, 0
    v_mov_b32 v115, 0
    v_mov_b32 v116, 0
    v_mov_b32 v117, 0
    v_mov_b32 v118, 0
    v_mov_b32 v119, 0
    v_mov_b32 v120, 0
    v_mov_b32 v121, 0
    v_mov_b32 v122, 0
    v_mov_b32 v123, 0
    v_mov_b32 v124, 0
    v_mov_b32 v125, 0
    v_mov_b32 v126, 0
    v_mov_b32 v127, 0
    v_mov_b32 v128, 0
    v_mov_b32 v129, 0
    v_mov_b32 v130, 0
    v_mov_b32 v131, 0
    v_mov_b32 v132, 0
    v_mov_b32 v133, 0
    v_mov_b32 v134, 0
    v_mov_b32 v135, 0
    v_mov_b32 v136, 0
    v_mov_b32 v137, 0
    v_mov_b32 v138, 0
    v_mov_b32 v139, 0
    v_mov_b32 v140, 0
    v_mov_b32 v141, 0
    v_mov_b32 v142, 0
    v_mov_b32 v143, 0
    v_mov_b32 v144, 0
    v_mov_b32 v145, 0
    v_mov_b32 v146, 0
    v_mov_b32 v147, 0
    v_mov_b32 v148, 0
    v_mov_b32 v149, 0
    v_mov_b32 v150, 0
    v_mov_b32 v151, 0
    v_mov_b32 v152, 0
    v_mov_b32 v153, 0
    v_mov_b32 v154, 0
    v_mov_b32 v155, 0
    v_mov_b32 v156, 0
    v_mov_b32 v157, 0
    v_mov_b32 v158, 0
    v_mov_b32 v159, 0
    v_mov_b32 v160, 0
    v_mov_b32 v161, 0
    v_mov_b32 v162, 0
    v_mov_b32 v163, 0
    v_mov_b32 v164, 0
    v_mov_b32 v165, 0
    v_mov_b32 v166, 0
    v_mov_b32 v167, 0
    v_mov_b32 v168, 0
    v_mov_b32 v169, 0
    v_mov_b32 v170, 0
    v_mov_b32 v171, 0
    v_mov_b32 v172, 0
    v_mov_b32 v173, 0
    v_mov_b32 v174, 0
    v_mov_b32 v175, 0
    v_mov_b32 v176, 0
    v_mov_b32 v177, 0
    v_mov_b32 v178, 0
    v_mov_b32 v179, 0
    v_mov_b32 v180, 0
    v_mov_b32 v181, 0
    v_mov_b32 v182, 0
    v_mov_b32 v183, 0
    v_mov_b32 v184, 0
    v_mov_b32 v185, 0
    v_mov_b32 v186, 0
    v_mov_b32 v187, 0
    v_mov_b32 v188, 0
    v_mov_b32 v189, 0
    v_mov_b32 v190, 0
    v_mov_b32 v191, 0
    v_mov_b32 v192, 0
    v_mov_b32 v193, 0
    v_mov_b32 v194, 0
    v_mov_b32 v195, 0
    v_mov_b32 v196, 0
    v_mov_b32 v197, 0
    v_mov_b32 v198, 0
    v_mov_b32 v199, 0
    v_mov_b32 v200, 0
    v_mov_b32 v201, 0
    v_mov_b32 v202, 0
    v_mov_b32 v203, 0
    v_mov_b32 v204, 0
    v_mov_b32 v205, 0
    v_mov_b32 v206, 0
    v_mov_b32 v207, 0
    s_lshl_b32 s40, s22, 22
    s_lshl_b32 s41, s25, 1
    s_add_u32 s41, s41, s32
    s_lshl_b32 s41, s41, 17
    s_add_u32 s40, s40, s41
    s_lshl_b32 s41, s24, 14
    s_add_u32 s40, s40, s41
    s_lshl_b32 s41, s31, 12
    s_add_u32 s40, s40, s41
    s_add_u32 s41, s40, 8388608
    s_add_u32 s42, s40, 16777216
    s_mov_b32 s43, 0x3e8293ee
    s_lshl_b32 s95, s25, 3
    s_add_u32 s95, s95, s24
    s_lshl_b32 s94, s95, 2
    s_add_u32 s94, s94, s31
    s_add_u32 s94, s94, 1408
    s_add_u32 s95, s95, 1280
    s_cmp_eq_u32 s22, 0
    s_cselect_b32 s95, s95, s94
    s_lshl_b32 s95, s95, 5
    s_add_u32 s95, s95, 33554432
    s_mov_b32 s80, s96
    s_mov_b32 s81, s97
    s_mov_b32 s82, 0x100
    s_mov_b32 s83, 0x00020000
    s_mov_b32 s33, 0
    s_mov_b32 s34, 98304
    s_mov_b32 s35, 0
    s_and_b32 s47, s21, 7
    s_bfe_u32 s51, s21, 0x10003
    s_add_u32 s51, s51, 2
    v_lshlrev_b32 v5, 11, v0
    v_lshrrev_b32 v6, 2, v0
    v_mul_u32_u24 v6, 6144, v6
    v_and_b32 v7, 3, v0
    v_lshl_add_u32 v6, v7, 7, v6
    v_mul_u32_u24 v7, 6144, v0
    s_cmp_lt_u32 s47, 4
    s_cselect_b64 s[56:57], -1, 0
    s_cselect_b32 s84, s88, s90
    s_cselect_b32 s85, s89, s91
    s_mov_b32 s86, 0x600000
    s_cselect_b32 s86, 0x400000, s86
    s_mov_b32 s87, 0x00020000
    s_mov_b32 s52, 393216
    s_cselect_b32 s52, 128, s52
    v_cndmask_b32 v28, v6, v5, s[56:57]
    s_and_b32 s48, s20, 1
    s_lshl_b32 s48, s48, 2
    s_add_u32 s48, s48, s47
    s_lshl_b32 s48, s48, 2
    s_add_u32 s48, s48, s31
    s_lshl_b32 s48, s48, 17
    s_lshl_b32 s50, s36, 9
    s_and_b32 s55, s47, 3
    s_lshl_b32 s55, s55, 11
    s_add_u32 s50, s50, s55
    s_mul_i32 s55, s31, 98304
    s_add_u32 s50, s50, s55
    s_cmp_lt_u32 s47, 4
    s_cselect_b32 s50, s48, s50
    s_and_b32 s48, s53, 2
    s_lshl_b32 s48, s48, 9
    s_lshl_b32 s55, s31, 11
    s_add_u32 s48, s48, s55
    s_add_u32 s48, s48, 384
    s_bitcmp1_b32 s53, 0
    s_cselect_b32 s90, s90, s6
    s_cselect_b32 s91, s91, s7
    s_cmp_eq_u32 s47, 7
    s_cselect_b64 s[56:57], -1, 0
    s_cselect_b32 s50, s48, s50
    s_cselect_b32 s84, s90, s84
    s_cselect_b32 s85, s91, s85
    s_cselect_b32 s55, 3, 0
    s_cselect_b32 s39, 12, 8
    v_cndmask_b32 v28, v28, v7, s[56:57]
    s_and_b32 s48, s55, s31
    s_cmp_eq_u32 s48, 3
    s_cselect_b32 s86, 0, s86
    s_lshl_b32 s49, s51, 1
    s_max_u32 s49, s49, s39
    s_sub_u32 s49, s49, s39
    s_cmp_eq_u32 s22, 0
    s_cselect_b32 s49, 0x7fff, s49
    s_add_u32 m0, s29, 0
    s_nop 0
    buffer_load_dwordx4 v10, s[12:15], s27 offen lds
    s_add_u32 m0, s29, 4096
    s_nop 0
    buffer_load_dwordx4 v11, s[12:15], s27 offen lds
    s_add_u32 m0, s29, 8192
    s_nop 0
    buffer_load_dwordx4 v12, s[12:15], s27 offen lds
    s_add_u32 s27, s27, 196608
    s_add_u32 s29, s29, 12288
    s_cmp_eq_u32 s29, s30
    s_cselect_b32 s38, 61440, 0
    s_sub_u32 s29, s29, s38
    s_cmp_ge_u32 s27, 0x600000
    s_cselect_b32 s38, 0x600000, 0
    s_sub_u32 s27, s27, s38
    s_add_u32 m0, s29, 0
    s_nop 0
    buffer_load_dwordx4 v10, s[12:15], s27 offen lds
    s_add_u32 m0, s29, 4096
    s_nop 0
    buffer_load_dwordx4 v11, s[12:15], s27 offen lds
    s_add_u32 m0, s29, 8192
    s_nop 0
    buffer_load_dwordx4 v12, s[12:15], s27 offen lds
    s_add_u32 s27, s27, 196608
    s_add_u32 s29, s29, 12288
    s_cmp_eq_u32 s29, s30
    s_cselect_b32 s38, 61440, 0
    s_sub_u32 s29, s29, s38
    s_add_u32 m0, s29, 0
    s_nop 0
    buffer_load_dwordx4 v10, s[12:15], s27 offen lds
    s_add_u32 m0, s29, 4096
    s_nop 0
    buffer_load_dwordx4 v11, s[12:15], s27 offen lds
    s_add_u32 m0, s29, 8192
    s_nop 0
    buffer_load_dwordx4 v12, s[12:15], s27 offen lds
    s_add_u32 s27, s27, 196608
    s_add_u32 s29, s29, 12288
    s_cmp_eq_u32 s29, s30
    s_cselect_b32 s38, 61440, 0
    s_sub_u32 s29, s29, s38
    s_cmp_ge_u32 s27, 0x600000
    s_cselect_b32 s38, 0x600000, 0
    s_sub_u32 s27, s27, s38
    s_cmp_eq_u32 s49, 0
    s_cbranch_scc1 L1W_e0
L1W_e0r:
    s_waitcnt vmcnt(9)
    s_barrier
    ds_read_b64_tr_b16 v[48:49], v24 offset:0
    ds_read_b64_tr_b16 v[50:51], v24 offset:512
    ds_read_b128 v[32:35], v20 offset:0
    ds_read_b128 v[36:39], v20 offset:2048
    ds_read_b128 v[40:43], v20 offset:4096
    ds_read_b128 v[44:47], v20 offset:6144
    ds_read_b64_tr_b16 v[52:53], v25 offset:0
    ds_read_b64_tr_b16 v[54:55], v25 offset:512
    ds_read_b64_tr_b16 v[56:57], v24 offset:4096
    ds_read_b64_tr_b16 v[58:59], v24 offset:4608
    ds_read_b64_tr_b16 v[60:61], v25 offset:4096
    ds_read_b64_tr_b16 v[62:63], v25 offset:4608
    ds_read_b64_tr_b16 v[64:65], v24 offset:8192
    ds_read_b64_tr_b16 v[66:67], v24 offset:8704
    ds_read_b64_tr_b16 v[68:69], v25 offset:8192
    ds_read_b64_tr_b16 v[70:71], v25 offset:8704
    s_add_u32 m0, s29, 0
    s_nop 0
    buffer_load_dwordx4 v10, s[12:15], s27 offen lds
    s_add_u32 m0, s29, 4096
    s_nop 0
    buffer_load_dwordx4 v11, s[12:15], s27 offen lds
    s_add_u32 m0, s29, 8192
    s_nop 0
    buffer_load_dwordx4 v12, s[12:15], s27 offen lds
    s_add_u32 s27, s27, 196608
    s_add_u32 s29, s29, 12288
    s_cmp_eq_u32 s29, s30
    s_cselect_b32 s38, 61440, 0
    s_sub_u32 s29, s29, s38
    s_add_u32 s34, s34, 12288
    s_cmp_eq_u32 s34, 159744
    s_cselect_b32 s34, 98304, s34
    v_add_u32 v24, s34, v22
    v_add_u32 v25, s34, v23
    s_add_u32 s35, s35, 1
    s_waitcnt vmcnt(9)
    s_waitcnt lgkmcnt(0)
    s_barrier
    s_setprio 1
    s_branch L1W_odd
.p2align 6
L1W_loop:
    v_mfma_f32_16x16x32_bf16 v[112:115], v[88:91], v[72:75], v[112:115]
    ds_read_b64_tr_b16 v[48:49], v24 offset:0
    s_add_u32 m0, s29, 0
    s_add_u32 s34, s34, 12288
    v_mfma_f32_16x16x32_bf16 v[136:139], v[88:91], v[76:79], v[136:139]
    buffer_load_dwordx4 v10, s[12:15], s27 offen lds
    s_cmp_eq_u32 s34, 159744
    s_cselect_b32 s34, 98304, s34
    v_mfma_f32_16x16x32_bf16 v[160:163], v[88:91], v[80:83], v[160:163]
    ds_read_b64_tr_b16 v[50:51], v24 offset:512
    s_add_u32 s35, s35, 1
    v_mfma_f32_16x16x32_bf16 v[184:187], v[88:91], v[84:87], v[184:187]
    ds_read_b128 v[32:35], v20 offset:0
    v_mfma_f32_16x16x32_bf16 v[116:119], v[92:95], v[72:75], v[116:119]
    ds_read_b128 v[36:39], v20 offset:2048
    s_add_u32 m0, s29, 4096
    v_mfma_f32_16x16x32_bf16 v[140:143], v[92:95], v[76:79], v[140:143]
    buffer_load_dwordx4 v11, s[12:15], s27 offen lds
    v_mfma_f32_16x16x32_bf16 v[164:167], v[92:95], v[80:83], v[164:167]
    ds_read_b128 v[40:43], v20 offset:4096
    v_mfma_f32_16x16x32_bf16 v[188:191], v[92:95], v[84:87], v[188:191]
    ds_read_b128 v[44:47], v20 offset:6144
    v_mfma_f32_16x16x32_bf16 v[120:123], v[96:99], v[72:75], v[120:123]
    ds_read_b64_tr_b16 v[52:53], v25 offset:0
    s_add_u32 m0, s29, 8192
    v_mfma_f32_16x16x32_bf16 v[144:147], v[96:99], v[76:79], v[144:147]
    buffer_load_dwordx4 v12, s[12:15], s27 offen lds
    s_add_u32 s27, s27, 196608
    s_add_u32 s29, s29, 12288
    v_mfma_f32_16x16x32_bf16 v[168:171], v[96:99], v[80:83], v[168:171]
    ds_read_b64_tr_b16 v[54:55], v25 offset:512
    s_cmp_eq_u32 s29, s30
    s_cselect_b32 s38, 61440, 0
    v_mfma_f32_16x16x32_bf16 v[192:195], v[96:99], v[84:87], v[192:195]
    ds_read_b64_tr_b16 v[56:57], v24 offset:4096
    s_sub_u32 s29, s29, s38
    v_mfma_f32_16x16x32_bf16 v[124:127], v[100:103], v[72:75], v[124:127]
    ds_read_b64_tr_b16 v[58:59], v24 offset:4608
    v_mfma_f32_16x16x32_bf16 v[148:151], v[100:103], v[76:79], v[148:151]
    ds_read_b64_tr_b16 v[60:61], v25 offset:4096
    v_mfma_f32_16x16x32_bf16 v[172:175], v[100:103], v[80:83], v[172:175]
    ds_read_b64_tr_b16 v[62:63], v25 offset:4608
    v_mfma_f32_16x16x32_bf16 v[196:199], v[100:103], v[84:87], v[196:199]
    ds_read_b64_tr_b16 v[64:65], v24 offset:8192
    v_mfma_f32_16x16x32_bf16 v[128:131], v[72:75], v[104:107], v[128:131]
    ds_read_b64_tr_b16 v[66:67], v24 offset:8704
    v_mfma_f32_16x16x32_bf16 v[152:155], v[76:79], v[104:107], v[152:155]
    ds_read_b64_tr_b16 v[68:69], v25 offset:8192
    v_mfma_f32_16x16x32_bf16 v[176:179], v[80:83], v[104:107], v[176:179]
    ds_read_b64_tr_b16 v[70:71], v25 offset:8704
    v_add_u32 v24, s34, v22
    v_add_u32 v25, s34, v23
    v_mfma_f32_16x16x32_bf16 v[200:203], v[84:87], v[104:107], v[200:203]
    v_mfma_f32_16x16x32_bf16 v[132:135], v[72:75], v[108:111], v[132:135]
    v_mfma_f32_16x16x32_bf16 v[156:159], v[76:79], v[108:111], v[156:159]
    v_mfma_f32_16x16x32_bf16 v[180:183], v[80:83], v[108:111], v[180:183]
    v_mfma_f32_16x16x32_bf16 v[204:207], v[84:87], v[108:111], v[204:207]
    s_cmp_ge_u32 s35, s49
    s_cbranch_scc1 L1W_e1
L1W_e1r:
    s_waitcnt vmcnt(9) lgkmcnt(0)
    s_barrier
L1W_odd:
    v_mfma_f32_16x16x32_bf16 v[112:115], v[48:51], v[32:35], v[112:115]
    ds_read_b64_tr_b16 v[88:89], v24 offset:0
    s_add_u32 m0, s29, 0
    s_add_u32 s34, s34, 12288
    v_mfma_f32_16x16x32_bf16 v[136:139], v[48:51], v[36:39], v[136:139]
    buffer_load_dwordx4 v10, s[12:15], s27 offen lds
    s_cmp_eq_u32 s34, 159744
    s_cselect_b32 s34, 98304, s34
    v_mfma_f32_16x16x32_bf16 v[160:163], v[48:51], v[40:43], v[160:163]
    ds_read_b64_tr_b16 v[90:91], v24 offset:512
    s_add_u32 s35, s35, 1
    s_add_u32 s33, s33, 32768
    v_mfma_f32_16x16x32_bf16 v[184:187], v[48:51], v[44:47], v[184:187]
    ds_read_b128 v[72:75], v21 offset:0
    s_cmp_eq_u32 s33, 98304
    s_cselect_b32 s33, 0, s33
    v_mfma_f32_16x16x32_bf16 v[116:119], v[52:55], v[32:35], v[116:119]
    ds_read_b128 v[76:79], v21 offset:2048
    s_add_u32 m0, s29, 4096
    v_mfma_f32_16x16x32_bf16 v[140:143], v[52:55], v[36:39], v[140:143]
    buffer_load_dwordx4 v11, s[12:15], s27 offen lds
    v_mfma_f32_16x16x32_bf16 v[164:167], v[52:55], v[40:43], v[164:167]
    ds_read_b128 v[80:83], v21 offset:4096
    v_mfma_f32_16x16x32_bf16 v[188:191], v[52:55], v[44:47], v[188:191]
    ds_read_b128 v[84:87], v21 offset:6144
    v_mfma_f32_16x16x32_bf16 v[120:123], v[56:59], v[32:35], v[120:123]
    ds_read_b64_tr_b16 v[92:93], v25 offset:0
    s_add_u32 m0, s29, 8192
    v_mfma_f32_16x16x32_bf16 v[144:147], v[56:59], v[36:39], v[144:147]
    buffer_load_dwordx4 v12, s[12:15], s27 offen lds
    s_add_u32 s27, s27, 196608
    s_add_u32 s29, s29, 12288
    v_mfma_f32_16x16x32_bf16 v[168:171], v[56:59], v[40:43], v[168:171]
    ds_read_b64_tr_b16 v[94:95], v25 offset:512
    s_cmp_eq_u32 s29, s30
    s_cselect_b32 s38, 61440, 0
    v_mfma_f32_16x16x32_bf16 v[192:195], v[56:59], v[44:47], v[192:195]
    ds_read_b64_tr_b16 v[96:97], v24 offset:4096
    s_sub_u32 s29, s29, s38
    v_mfma_f32_16x16x32_bf16 v[124:127], v[60:63], v[32:35], v[124:127]
    ds_read_b64_tr_b16 v[98:99], v24 offset:4608
    s_cmp_ge_u32 s27, 0x600000
    s_cselect_b32 s38, 0x600000, 0
    v_mfma_f32_16x16x32_bf16 v[148:151], v[60:63], v[36:39], v[148:151]
    ds_read_b64_tr_b16 v[100:101], v25 offset:4096
    s_sub_u32 s27, s27, s38
    v_mfma_f32_16x16x32_bf16 v[172:175], v[60:63], v[40:43], v[172:175]
    ds_read_b64_tr_b16 v[102:103], v25 offset:4608
    v_mfma_f32_16x16x32_bf16 v[196:199], v[60:63], v[44:47], v[196:199]
    ds_read_b64_tr_b16 v[104:105], v24 offset:8192
    v_mfma_f32_16x16x32_bf16 v[128:131], v[32:35], v[64:67], v[128:131]
    ds_read_b64_tr_b16 v[106:107], v24 offset:8704
    v_mfma_f32_16x16x32_bf16 v[152:155], v[36:39], v[64:67], v[152:155]
    ds_read_b64_tr_b16 v[108:109], v25 offset:8192
    v_mfma_f32_16x16x32_bf16 v[176:179], v[40:43], v[64:67], v[176:179]
    ds_read_b64_tr_b16 v[110:111], v25 offset:8704
    v_add_u32 v24, s34, v22
    v_add_u32 v25, s34, v23
    v_mfma_f32_16x16x32_bf16 v[200:203], v[44:47], v[64:67], v[200:203]
    v_add_u32 v20, s33, v18
    v_add_u32 v21, s33, v19
    v_mfma_f32_16x16x32_bf16 v[132:135], v[32:35], v[68:71], v[132:135]
    v_mfma_f32_16x16x32_bf16 v[156:159], v[36:39], v[68:71], v[156:159]
    v_mfma_f32_16x16x32_bf16 v[180:183], v[40:43], v[68:71], v[180:183]
    v_mfma_f32_16x16x32_bf16 v[204:207], v[44:47], v[68:71], v[204:207]
    s_cmp_ge_u32 s35, s49
    s_cbranch_scc1 L1W_e2
L1W_e2r:
    s_cmp_lt_u32 s35, 28
    s_waitcnt vmcnt(9) lgkmcnt(0)
    s_barrier
    s_cbranch_scc1 L1W_loop
    s_branch L1_epi
L1W_e0:
    s_cmp_ge_u32 s51, 0x100
    s_cbranch_scc1 L1W_e0c
    s_add_u32 s48, s54, s51
    s_and_b32 s48, s48, 15
    s_mul_i32 s48, s48, s52
    s_add_u32 s48, s48, s50
    buffer_load_dword v29, v28, s[84:87], s48 offen
    s_add_u32 s51, s51, 2
    s_lshl_b32 s49, s51, 1
    s_max_u32 s49, s49, s39
    s_sub_u32 s49, s49, s39
    s_cmp_lt_u32 s51, 6
    s_cbranch_scc1 L1W_e0r
    s_mov_b32 s49, 0x7fff
    s_cmp_eq_u32 s31, 3
    s_cselect_b32 s49, 16, s49
    s_mov_b32 s51, 0x100
    s_branch L1W_e0r
L1W_e0c:
    s_mov_b32 s49, 0x7fff
    s_getpc_b64 s[56:57]
Lcp2:
    s_add_u32 s56, s56, L1_epi-Lcp2
    s_addc_u32 s57, s57, (L1_epi-Lcp2)>>32
    v_lshlrev_b32 v31, 7, v0
    v_min_u32 v31, (L1_epi+8192)-(L1_epi)-4, v31
    global_load_dword v31, v31, s[56:57]
    s_getpc_b64 s[56:57]
Lcp3:
    s_add_u32 s56, s56, L1_epi+8192-Lcp3
    s_addc_u32 s57, s57, (L1_epi+8192-Lcp3)>>32
    v_lshlrev_b32 v9, 7, v0
    v_min_u32 v9, (L1_epi+16384)-(L1_epi+8192)-4, v9
    global_load_dword v9, v9, s[56:57]
    s_getpc_b64 s[56:57]
Lcp4:
    s_add_u32 s56, s56, L1_epi+16384-Lcp4
    s_addc_u32 s57, s57, (L1_epi+16384-Lcp4)>>32
    v_lshlrev_b32 v8, 7, v0
    v_min_u32 v8, (L2_slow0)-(L1_epi+16384)-4, v8
    global_load_dword v8, v8, s[56:57]
    s_branch L1W_e0r
L1W_e1:
    s_cmp_ge_u32 s51, 0x100
    s_cbranch_scc1 L1W_e1c
    s_add_u32 s48, s54, s51
    s_and_b32 s48, s48, 15
    s_mul_i32 s48, s48, s52
    s_add_u32 s48, s48, s50
    buffer_load_dword v29, v28, s[84:87], s48 offen
    s_add_u32 s51, s51, 2
    s_lshl_b32 s49, s51, 1
    s_max_u32 s49, s49, s39
    s_sub_u32 s49, s49, s39
    s_cmp_lt_u32 s51, 6
    s_cbranch_scc1 L1W_e1r
    s_mov_b32 s49, 0x7fff
    s_cmp_eq_u32 s31, 3
    s_cselect_b32 s49, 16, s49
    s_mov_b32 s51, 0x100
    s_branch L1W_e1r
L1W_e1c:
    s_mov_b32 s49, 0x7fff
    s_getpc_b64 s[56:57]
Lcp5:
    s_add_u32 s56, s56, L1_epi-Lcp5
    s_addc_u32 s57, s57, (L1_epi-Lcp5)>>32
    v_lshlrev_b32 v31, 7, v0
    v_min_u32 v31, (L1_epi+8192)-(L1_epi)-4, v31
    global_load_dword v31, v31, s[56:57]
    s_getpc_b64 s[56:57]
Lcp6:
    s_add_u32 s56, s56, L1_epi+8192-Lcp6
    s_addc_u32 s57, s57, (L1_epi+8192-Lcp6)>>32
    v_lshlrev_b32 v9, 7, v0
    v_min_u32 v9, (L1_epi+16384)-(L1_epi+8192)-4, v9
    global_load_dword v9, v9, s[56:57]
    s_getpc_b64 s[56:57]
Lcp7:
    s_add_u32 s56, s56, L1_epi+16384-Lcp7
    s_addc_u32 s57, s57, (L1_epi+16384-Lcp7)>>32
    v_lshlrev_b32 v8, 7, v0
    v_min_u32 v8, (L2_slow0)-(L1_epi+16384)-4, v8
    global_load_dword v8, v8, s[56:57]
    s_branch L1W_e1r
L1W_e2:
    s_cmp_ge_u32 s51, 0x100
    s_cbranch_scc1 L1W_e2c
    s_add_u32 s48, s54, s51
    s_and_b32 s48, s48, 15
    s_mul_i32 s48, s48, s52
    s_add_u32 s48, s48, s50
    buffer_load_dword v29, v28, s[84:87], s48 offen
    s_add_u32 s51, s51, 2
    s_lshl_b32 s49, s51, 1
    s_max_u32 s49, s49, s39
    s_sub_u32 s49, s49, s39
    s_cmp_lt_u32 s51, 6
    s_cbranch_scc1 L1W_e2r
    s_mov_b32 s49, 0x7fff
    s_cmp_eq_u32 s31, 3
    s_cselect_b32 s49, 16, s49
    s_mov_b32 s51, 0x100
    s_branch L1W_e2r
L1W_e2c:
    s_mov_b32 s49, 0x7fff
    s_getpc_b64 s[56:57]
Lcp8:
    s_add_u32 s56, s56, L1_epi-Lcp8
    s_addc_u32 s57, s57, (L1_epi-Lcp8)>>32
    v_lshlrev_b32 v31, 7, v0
    v_min_u32 v31, (L1_epi+8192)-(L1_epi)-4, v31
    global_load_dword v31, v31, s[56:57]
    s_getpc_b64 s[56:57]
Lcp9:
    s_add_u32 s56, s56, L1_epi+8192-Lcp9
    s_addc_u32 s57, s57, (L1_epi+8192-Lcp9)>>32
    v_lshlrev_b32 v9, 7, v0
    v_min_u32 v9, (L1_epi+16384)-(L1_epi+8192)-4, v9
    global_load_dword v9, v9, s[56:57]
    s_getpc_b64 s[56:57]
Lcp10:
    s_add_u32 s56, s56, L1_epi+16384-Lcp10
    s_addc_u32 s57, s57, (L1_epi+16384-Lcp10)>>32
    v_lshlrev_b32 v8, 7, v0
    v_min_u32 v8, (L2_slow0)-(L1_epi+16384)-4, v8
    global_load_dword v8, v8, s[56:57]
    s_branch L1W_e2r
L1_epi:
    v_mov_b32 v9, 0
    s_mov_b32 s44, s43
    s_mov_b32 s45, s43
    v_add_u32 v24, 98304, v22
    v_add_u32 v25, 98304, v23
    s_and_b32 s33, s22, s32
    s_cselect_b32 s18, 0, s18
    v_mfma_f32_16x16x32_bf16 v[112:115], v[88:91], v[72:75], v[112:115]
    ds_read_b128 v[32:35], v20 offset:0
    v_mfma_f32_16x16x32_bf16 v[136:139], v[88:91], v[76:79], v[136:139]
    ds_read_b128 v[36:39], v20 offset:2048
    v_mfma_f32_16x16x32_bf16 v[160:163], v[88:91], v[80:83], v[160:163]
    ds_read_b128 v[40:43], v20 offset:4096
    v_mfma_f32_16x16x32_bf16 v[184:187], v[88:91], v[84:87], v[184:187]
    ds_read_b128 v[44:47], v20 offset:6144
    v_mfma_f32_16x16x32_bf16 v[116:119], v[92:95], v[72:75], v[116:119]
    ds_read_b64_tr_b16 v[64:65], v24 offset:36864
    v_mfma_f32_16x16x32_bf16 v[140:143], v[92:95], v[76:79], v[140:143]
    ds_read_b64_tr_b16 v[66:67], v24 offset:37376
    v_mfma_f32_16x16x32_bf16 v[164:167], v[92:95], v[80:83], v[164:167]
    ds_read_b64_tr_b16 v[68:69], v25 offset:36864
    v_mfma_f32_16x16x32_bf16 v[188:191], v[92:95], v[84:87], v[188:191]
    ds_read_b64_tr_b16 v[70:71], v25 offset:37376
    v_mfma_f32_16x16x32_bf16 v[120:123], v[96:99], v[72:75], v[120:123]
    ds_read_b64_tr_b16 v[240:241], v24 offset:40960
    v_mfma_f32_16x16x32_bf16 v[144:147], v[96:99], v[76:79], v[144:147]
    ds_read_b64_tr_b16 v[242:243], v24 offset:41472
    v_mfma_f32_16x16x32_bf16 v[168:171], v[96:99], v[80:83], v[168:171]
    ds_read_b64_tr_b16 v[244:245], v25 offset:40960
    v_mfma_f32_16x16x32_bf16 v[192:195], v[96:99], v[84:87], v[192:195]
    ds_read_b64_tr_b16 v[246:247], v25 offset:41472
    v_mfma_f32_16x16x32_bf16 v[124:127], v[100:103], v[72:75], v[124:127]
    ds_read_b128 v[48:51], v21 offset:0
    v_mfma_f32_16x16x32_bf16 v[148:151], v[100:103], v[76:79], v[148:151]
    ds_read_b128 v[52:55], v21 offset:2048
    v_mfma_f32_16x16x32_bf16 v[172:175], v[100:103], v[80:83], v[172:175]
    ds_read_b128 v[56:59], v21 offset:4096
    v_mfma_f32_16x16x32_bf16 v[196:199], v[100:103], v[84:87], v[196:199]
    ds_read_b128 v[60:63], v21 offset:6144
    v_mfma_f32_16x16x32_bf16 v[128:131], v[72:75], v[104:107], v[128:131]
    v_mfma_f32_16x16x32_bf16 v[152:155], v[76:79], v[104:107], v[152:155]
    v_mfma_f32_16x16x32_bf16 v[176:179], v[80:83], v[104:107], v[176:179]
    v_mfma_f32_16x16x32_bf16 v[200:203], v[84:87], v[104:107], v[200:203]
    v_mfma_f32_16x16x32_bf16 v[132:135], v[72:75], v[108:111], v[132:135]
    v_mfma_f32_16x16x32_bf16 v[156:159], v[76:79], v[108:111], v[156:159]
    v_mfma_f32_16x16x32_bf16 v[180:183], v[80:83], v[108:111], v[180:183]
    v_mfma_f32_16x16x32_bf16 v[204:207], v[84:87], v[108:111], v[204:207]
    s_waitcnt vmcnt(6)
    s_barrier
    s_waitcnt lgkmcnt(8)
    v_mfma_f32_16x16x32_bf16 v[112:115], v[64:67], v[32:35], v[112:115]
    ds_read_b64_tr_b16 v[248:249], v24 offset:49152
    v_mfma_f32_16x16x32_bf16 v[136:139], v[64:67], v[36:39], v[136:139]
    ds_read_b64_tr_b16 v[250:251], v24 offset:49664
    v_mfma_f32_16x16x32_bf16 v[160:163], v[64:67], v[40:43], v[160:163]
    ds_read_b64_tr_b16 v[252:253], v25 offset:49152
    v_mfma_f32_16x16x32_bf16 v[184:187], v[64:67], v[44:47], v[184:187]
    ds_read_b64_tr_b16 v[254:255], v25 offset:49664
    v_mfma_f32_16x16x32_bf16 v[116:119], v[68:71], v[32:35], v[116:119]
    v_mfma_f32_16x16x32_bf16 v[140:143], v[68:71], v[36:39], v[140:143]
    v_mfma_f32_16x16x32_bf16 v[164:167], v[68:71], v[40:43], v[164:167]
    v_mfma_f32_16x16x32_bf16 v[188:191], v[68:71], v[44:47], v[188:191]
    s_waitcnt vmcnt(0)
    s_barrier
    s_cmp_lg_u32 s26, 5
    s_cbranch_scc1 L1_noc
    buffer_load_dword v8, v9, s[80:83], 0 offen sc1
L1_noc:
    s_waitcnt lgkmcnt(8)
    v_mfma_f32_16x16x32_bf16 v[120:123], v[240:243], v[32:35], v[120:123]
    ds_read_b128 v[72:75], v18 offset:0
    v_mfma_f32_16x16x32_bf16 v[144:147], v[240:243], v[36:39], v[144:147]
    ds_read_b128 v[76:79], v18 offset:2048
    v_mfma_f32_16x16x32_bf16 v[168:171], v[240:243], v[40:43], v[168:171]
    ds_read_b128 v[80:83], v18 offset:4096
    v_mfma_f32_16x16x32_bf16 v[192:195], v[240:243], v[44:47], v[192:195]
    ds_read_b128 v[84:87], v18 offset:6144
    v_mfma_f32_16x16x32_bf16 v[124:127], v[244:247], v[32:35], v[124:127]
    ds_read_b64_tr_b16 v[104:105], v24 offset:0
    v_mfma_f32_16x16x32_bf16 v[148:151], v[244:247], v[36:39], v[148:151]
    ds_read_b64_tr_b16 v[106:107], v24 offset:512
    v_mfma_f32_16x16x32_bf16 v[172:175], v[244:247], v[40:43], v[172:175]
    ds_read_b64_tr_b16 v[108:109], v25 offset:0
    v_mfma_f32_16x16x32_bf16 v[196:199], v[244:247], v[44:47], v[196:199]
    ds_read_b64_tr_b16 v[110:111], v25 offset:512
    s_waitcnt lgkmcnt(8)
    v_mfma_f32_16x16x32_bf16 v[112:115], v[248:251], v[48:51], v[112:115]
    ds_read_b128 v[88:91], v19 offset:0
    v_mfma_f32_16x16x32_bf16 v[136:139], v[248:251], v[52:55], v[136:139]
    ds_read_b128 v[92:95], v19 offset:2048
    v_mfma_f32_16x16x32_bf16 v[160:163], v[248:251], v[56:59], v[160:163]
    ds_read_b128 v[96:99], v19 offset:4096
    v_mfma_f32_16x16x32_bf16 v[184:187], v[248:251], v[60:63], v[184:187]
    ds_read_b128 v[100:103], v19 offset:6144
    v_mfma_f32_16x16x32_bf16 v[116:119], v[252:255], v[48:51], v[116:119]
    ds_read_b64_tr_b16 v[64:65], v24 offset:12288
    v_mfma_f32_16x16x32_bf16 v[140:143], v[252:255], v[52:55], v[140:143]
    ds_read_b64_tr_b16 v[66:67], v24 offset:12800
    v_mfma_f32_16x16x32_bf16 v[164:167], v[252:255], v[56:59], v[164:167]
    ds_read_b64_tr_b16 v[68:69], v25 offset:12288
    v_mfma_f32_16x16x32_bf16 v[188:191], v[252:255], v[60:63], v[188:191]
    ds_read_b64_tr_b16 v[70:71], v25 offset:12800
    s_waitcnt lgkmcnt(8)
    v_mfma_f32_16x16x32_bf16 v[112:115], v[104:107], v[72:75], v[112:115]
    ds_read_b64_tr_b16 v[240:241], v24 offset:53248
    v_mfma_f32_16x16x32_bf16 v[136:139], v[104:107], v[76:79], v[136:139]
    ds_read_b64_tr_b16 v[242:243], v24 offset:53760
    v_mfma_f32_16x16x32_bf16 v[160:163], v[104:107], v[80:83], v[160:163]
    ds_read_b64_tr_b16 v[244:245], v25 offset:53248
    v_mfma_f32_16x16x32_bf16 v[184:187], v[104:107], v[84:87], v[184:187]
    ds_read_b64_tr_b16 v[246:247], v25 offset:53760
    v_mfma_f32_16x16x32_bf16 v[116:119], v[108:111], v[72:75], v[116:119]
    v_mfma_f32_16x16x32_bf16 v[140:143], v[108:111], v[76:79], v[140:143]
    v_mfma_f32_16x16x32_bf16 v[164:167], v[108:111], v[80:83], v[164:167]
    v_mfma_f32_16x16x32_bf16 v[188:191], v[108:111], v[84:87], v[188:191]
    s_waitcnt lgkmcnt(4)
    v_mfma_f32_16x16x32_bf16 v[112:115], v[64:67], v[88:91], v[112:115]
    ds_read_b64_tr_b16 v[248:249], v24 offset:4096
    v_mfma_f32_16x16x32_bf16 v[136:139], v[64:67], v[92:95], v[136:139]
    ds_read_b64_tr_b16 v[250:251], v24 offset:4608
    v_mfma_f32_16x16x32_bf16 v[160:163], v[64:67], v[96:99], v[160:163]
    ds_read_b64_tr_b16 v[252:253], v25 offset:4096
    v_mfma_f32_16x16x32_bf16 v[184:187], v[64:67], v[100:103], v[184:187]
    ds_read_b64_tr_b16 v[254:255], v25 offset:4608
    v_mfma_f32_16x16x32_bf16 v[116:119], v[68:71], v[88:91], v[116:119]
    v_mfma_f32_16x16x32_bf16 v[140:143], v[68:71], v[92:95], v[140:143]
    v_mfma_f32_16x16x32_bf16 v[164:167], v[68:71], v[96:99], v[164:167]
    v_mfma_f32_16x16x32_bf16 v[188:191], v[68:71], v[100:103], v[188:191]
    s_waitcnt lgkmcnt(4)
    v_mfma_f32_16x16x32_bf16 v[120:123], v[240:243], v[48:51], v[120:123]
    ds_read_b64_tr_b16 v[104:105], v24 offset:16384
    v_mfma_f32_16x16x32_bf16 v[144:147], v[240:243], v[52:55], v[144:147]
    ds_read_b64_tr_b16 v[106:107], v24 offset:16896
    v_mfma_f32_16x16x32_bf16 v[168:171], v[240:243], v[56:59], v[168:171]
    ds_read_b64_tr_b16 v[108:109], v25 offset:16384
    v_mfma_f32_16x16x32_bf16 v[192:195], v[240:243], v[60:63], v[192:195]
    ds_read_b64_tr_b16 v[110:111], v25 offset:16896
    v_pk_mul_f32 v[112:113], v[112:113], s[44:45]
    v_mfma_f32_16x16x32_bf16 v[124:127], v[244:247], v[48:51], v[124:127]
    v_pk_mul_f32 v[114:115], v[114:115], s[44:45]
    v_pk_mul_f32 v[116:117], v[116:117], s[44:45]
    v_mfma_f32_16x16x32_bf16 v[148:151], v[244:247], v[52:55], v[148:151]
    v_pk_mul_f32 v[118:119], v[118:119], s[44:45]
    v_cvt_pk_bf16_f32 v224, v112, v113
    v_mfma_f32_16x16x32_bf16 v[172:175], v[244:247], v[56:59], v[172:175]
    v_cvt_pk_bf16_f32 v225, v114, v115
    v_cvt_pk_bf16_f32 v226, v116, v117
    v_mfma_f32_16x16x32_bf16 v[196:199], v[244:247], v[60:63], v[196:199]
    v_cvt_pk_bf16_f32 v227, v118, v119
    buffer_store_dwordx4 v[224:227], v26, s[16:19], s40 offen offset:0 sc1
    s_waitcnt lgkmcnt(4)
    v_mfma_f32_16x16x32_bf16 v[120:123], v[248:251], v[72:75], v[120:123]
    ds_read_b64_tr_b16 v[64:65], v24 offset:45056
    v_pk_mul_f32 v[136:137], v[136:137], s[44:45]
    v_mfma_f32_16x16x32_bf16 v[144:147], v[248:251], v[76:79], v[144:147]
    ds_read_b64_tr_b16 v[66:67], v24 offset:45568
    v_pk_mul_f32 v[138:139], v[138:139], s[44:45]
    v_mfma_f32_16x16x32_bf16 v[168:171], v[248:251], v[80:83], v[168:171]
    ds_read_b64_tr_b16 v[68:69], v25 offset:45056
    v_pk_mul_f32 v[140:141], v[140:141], s[44:45]
    v_mfma_f32_16x16x32_bf16 v[192:195], v[248:251], v[84:87], v[192:195]
    ds_read_b64_tr_b16 v[70:71], v25 offset:45568
    v_pk_mul_f32 v[142:143], v[142:143], s[44:45]
    v_mfma_f32_16x16x32_bf16 v[124:127], v[252:255], v[72:75], v[124:127]
    v_cvt_pk_bf16_f32 v228, v136, v137
    v_cvt_pk_bf16_f32 v229, v138, v139
    v_mfma_f32_16x16x32_bf16 v[148:151], v[252:255], v[76:79], v[148:151]
    v_cvt_pk_bf16_f32 v230, v140, v141
    v_cvt_pk_bf16_f32 v231, v142, v143
    v_mfma_f32_16x16x32_bf16 v[172:175], v[252:255], v[80:83], v[172:175]
    buffer_store_dwordx4 v[228:231], v26, s[16:19], s40 offen offset:256 sc1
    v_pk_mul_f32 v[160:161], v[160:161], s[44:45]
    v_mfma_f32_16x16x32_bf16 v[196:199], v[252:255], v[84:87], v[196:199]
    v_pk_mul_f32 v[162:163], v[162:163], s[44:45]
    v_pk_mul_f32 v[164:165], v[164:165], s[44:45]
    s_waitcnt lgkmcnt(4)
    v_mfma_f32_16x16x32_bf16 v[120:123], v[104:107], v[88:91], v[120:123]
    ds_read_b64_tr_b16 v[240:241], v24 offset:57344
    v_pk_mul_f32 v[166:167], v[166:167], s[44:45]
    v_mfma_f32_16x16x32_bf16 v[144:147], v[104:107], v[92:95], v[144:147]
    ds_read_b64_tr_b16 v[242:243], v24 offset:57856
    v_cvt_pk_bf16_f32 v232, v160, v161
    v_mfma_f32_16x16x32_bf16 v[168:171], v[104:107], v[96:99], v[168:171]
    ds_read_b64_tr_b16 v[244:245], v25 offset:57344
    v_cvt_pk_bf16_f32 v233, v162, v163
    v_mfma_f32_16x16x32_bf16 v[192:195], v[104:107], v[100:103], v[192:195]
    ds_read_b64_tr_b16 v[246:247], v25 offset:57856
    v_cvt_pk_bf16_f32 v234, v164, v165
    v_mfma_f32_16x16x32_bf16 v[124:127], v[108:111], v[88:91], v[124:127]
    v_cvt_pk_bf16_f32 v235, v166, v167
    buffer_store_dwordx4 v[232:235], v26, s[16:19], s40 offen offset:2048 sc1
    v_mfma_f32_16x16x32_bf16 v[148:151], v[108:111], v[92:95], v[148:151]
    v_pk_mul_f32 v[184:185], v[184:185], s[44:45]
    v_pk_mul_f32 v[186:187], v[186:187], s[44:45]
    v_mfma_f32_16x16x32_bf16 v[172:175], v[108:111], v[96:99], v[172:175]
    v_pk_mul_f32 v[188:189], v[188:189], s[44:45]
    v_pk_mul_f32 v[190:191], v[190:191], s[44:45]
    v_mfma_f32_16x16x32_bf16 v[196:199], v[108:111], v[100:103], v[196:199]
    v_cvt_pk_bf16_f32 v236, v184, v185
    v_cvt_pk_bf16_f32 v237, v186, v187
    s_waitcnt lgkmcnt(4)
    v_mfma_f32_16x16x32_bf16 v[128:131], v[32:35], v[64:67], v[128:131]
    ds_read_b64_tr_b16 v[248:249], v24 offset:8192
    v_mfma_f32_16x16x32_bf16 v[152:155], v[36:39], v[64:67], v[152:155]
    ds_read_b64_tr_b16 v[250:251], v24 offset:8704
    v_mfma_f32_16x16x32_bf16 v[176:179], v[40:43], v[64:67], v[176:179]
    ds_read_b64_tr_b16 v[252:253], v25 offset:8192
    v_mfma_f32_16x16x32_bf16 v[200:203], v[44:47], v[64:67], v[200:203]
    ds_read_b64_tr_b16 v[254:255], v25 offset:8704
    v_cvt_pk_bf16_f32 v238, v188, v189
    v_mfma_f32_16x16x32_bf16 v[132:135], v[32:35], v[68:71], v[132:135]
    v_cvt_pk_bf16_f32 v239, v190, v191
    buffer_store_dwordx4 v[236:239], v26, s[16:19], s40 offen offset:2304 sc1
    v_mfma_f32_16x16x32_bf16 v[156:159], v[36:39], v[68:71], v[156:159]
    v_cvt_pk_bf16_f32 v208, v120, v121
    v_cvt_pk_bf16_f32 v209, v122, v123
    v_mfma_f32_16x16x32_bf16 v[180:183], v[40:43], v[68:71], v[180:183]
    v_cvt_pk_bf16_f32 v210, v124, v125
    v_cvt_pk_bf16_f32 v211, v126, v127
    v_mfma_f32_16x16x32_bf16 v[204:207], v[44:47], v[68:71], v[204:207]
    buffer_store_dwordx4 v[208:211], v26, s[16:19], s41 offen offset:0 sc1
    v_cvt_pk_bf16_f32 v212, v144, v145
    s_waitcnt lgkmcnt(4)
    v_mfma_f32_16x16x32_bf16 v[128:131], v[48:51], v[240:243], v[128:131]
    ds_read_b64_tr_b16 v[104:105], v24 offset:20480
    v_cvt_pk_bf16_f32 v213, v146, v147
    v_mfma_f32_16x16x32_bf16 v[152:155], v[52:55], v[240:243], v[152:155]
    ds_read_b64_tr_b16 v[106:107], v24 offset:20992
    v_cvt_pk_bf16_f32 v214, v148, v149
    v_mfma_f32_16x16x32_bf16 v[176:179], v[56:59], v[240:243], v[176:179]
    ds_read_b64_tr_b16 v[108:109], v25 offset:20480
    v_cvt_pk_bf16_f32 v215, v150, v151
    v_mfma_f32_16x16x32_bf16 v[200:203], v[60:63], v[240:243], v[200:203]
    ds_read_b64_tr_b16 v[110:111], v25 offset:20992
    v_mfma_f32_16x16x32_bf16 v[132:135], v[48:51], v[244:247], v[132:135]
    buffer_store_dwordx4 v[212:215], v26, s[16:19], s41 offen offset:256 sc1
    v_cvt_pk_bf16_f32 v216, v168, v169
    v_mfma_f32_16x16x32_bf16 v[156:159], v[52:55], v[244:247], v[156:159]
    v_cvt_pk_bf16_f32 v217, v170, v171
    v_cvt_pk_bf16_f32 v218, v172, v173
    v_mfma_f32_16x16x32_bf16 v[180:183], v[56:59], v[244:247], v[180:183]
    v_cvt_pk_bf16_f32 v219, v174, v175
    buffer_store_dwordx4 v[216:219], v26, s[16:19], s41 offen offset:2048 sc1
    v_mfma_f32_16x16x32_bf16 v[204:207], v[60:63], v[244:247], v[204:207]
    v_cvt_pk_bf16_f32 v220, v192, v193
    v_cvt_pk_bf16_f32 v221, v194, v195
    s_waitcnt lgkmcnt(4)
    v_mfma_f32_16x16x32_bf16 v[128:131], v[72:75], v[248:251], v[128:131]
    v_cvt_pk_bf16_f32 v222, v196, v197
    v_cvt_pk_bf16_f32 v223, v198, v199
    v_mfma_f32_16x16x32_bf16 v[152:155], v[76:79], v[248:251], v[152:155]
    buffer_store_dwordx4 v[220:223], v26, s[16:19], s41 offen offset:2304 sc1
    v_mfma_f32_16x16x32_bf16 v[176:179], v[80:83], v[248:251], v[176:179]
    v_mfma_f32_16x16x32_bf16 v[200:203], v[84:87], v[248:251], v[200:203]
    v_mfma_f32_16x16x32_bf16 v[132:135], v[72:75], v[252:255], v[132:135]
    v_mfma_f32_16x16x32_bf16 v[156:159], v[76:79], v[252:255], v[156:159]
    v_mfma_f32_16x16x32_bf16 v[180:183], v[80:83], v[252:255], v[180:183]
    v_mfma_f32_16x16x32_bf16 v[204:207], v[84:87], v[252:255], v[204:207]
    s_waitcnt lgkmcnt(0)
    v_mfma_f32_16x16x32_bf16 v[128:131], v[88:91], v[104:107], v[128:131]
    v_mfma_f32_16x16x32_bf16 v[152:155], v[92:95], v[104:107], v[152:155]
    v_mfma_f32_16x16x32_bf16 v[176:179], v[96:99], v[104:107], v[176:179]
    v_mfma_f32_16x16x32_bf16 v[200:203], v[100:103], v[104:107], v[200:203]
    v_mfma_f32_16x16x32_bf16 v[132:135], v[88:91], v[108:111], v[132:135]
    v_mfma_f32_16x16x32_bf16 v[156:159], v[92:95], v[108:111], v[156:159]
    v_mfma_f32_16x16x32_bf16 v[180:183], v[96:99], v[108:111], v[180:183]
    v_mfma_f32_16x16x32_bf16 v[204:207], v[100:103], v[108:111], v[204:207]
    s_nop 1
    s_cmp_lg_u32 s22, 0
    s_cselect_b32 s18, 0, s18
    v_cvt_pk_bf16_f32 v240, v128, v129
    v_cvt_pk_bf16_f32 v241, v130, v131
    v_cvt_pk_bf16_f32 v242, v152, v153
    v_cvt_pk_bf16_f32 v243, v154, v155
    buffer_store_dwordx4 v[240:243], v26, s[16:19], s42 offen offset:0 sc1
    v_cvt_pk_bf16_f32 v248, v176, v177
    v_cvt_pk_bf16_f32 v249, v178, v179
    v_cvt_pk_bf16_f32 v250, v200, v201
    v_cvt_pk_bf16_f32 v251, v202, v203
    buffer_store_dwordx4 v[248:251], v26, s[16:19], s42 offen offset:2048 sc1
    v_cvt_pk_bf16_f32 v244, v132, v133
    v_cvt_pk_bf16_f32 v245, v134, v135
    v_cvt_pk_bf16_f32 v246, v156, v157
    v_cvt_pk_bf16_f32 v247, v158, v159
    buffer_store_dwordx4 v[244:247], v26, s[16:19], s42 offen offset:256 sc1
    v_cvt_pk_bf16_f32 v252, v180, v181
    v_cvt_pk_bf16_f32 v253, v182, v183
    v_cvt_pk_bf16_f32 v254, v204, v205
    v_cvt_pk_bf16_f32 v255, v206, v207
    buffer_store_dwordx4 v[252:255], v26, s[16:19], s42 offen offset:2304 sc1
L1_done:
    s_setprio 0
    v_mov_b32 v200, v26
    s_mov_b32 s92, s40
    s_mov_b32 s93, s41
    s_mov_b32 s94, s42
    s_mov_b32 s24, s26
    s_lshr_b32 s60, s21, 4
    s_mul_i32 s22, s60, 24
    s_add_u32 s22, s22, 16
    s_load_dwordx2 s[6:7], s[0:1], s22
    s_load_dwordx2 s[58:59], s[0:1], 48
    s_lshl_b32 s22, s20, 2
    s_lshr_b32 s23, s21, 3
    s_add_u32 s22, s22, s23
    s_and_b32 s23, s21, 7
    v_lshlrev_b32 v1, 4, v0
    s_and_b32 s28, s24, 3
    s_lshl_b32 s25, s23, 3
    s_lshl_b32 s29, s28, 1
    s_add_u32 s25, s25, s29
    s_lshl_b32 s26, s22, 17
    s_lshl_b32 s27, s25, 11
    s_add_u32 s27, s27, s26
    v_bfe_u32 v5, v0, 2, 1
    v_and_b32 v6, 0x23, v0
    v_lshl_or_b32 v6, v5, 4, v6
    v_bfe_u32 v5, v0, 3, 2
    v_lshl_or_b32 v6, v5, 2, v6
    v_lshlrev_b32 v7, 4, v6
    s_add_u32 s33, s26, 8388608
    s_lshl_b32 s37, s25, 16
    s_lshl_b32 s38, s22, 11
    s_add_u32 s37, s37, s38
    s_add_u32 s37, s37, 25165824
    s_lshr_b32 s61, s20, 1
    s_lshl_b32 s61, s61, 2
    s_and_b32 s62, s21, 3
    s_add_u32 s61, s61, s62
    s_and_b32 s62, s20, 1
    s_lshl_b32 s62, s62, 2
    s_bfe_u32 s63, s21, 0x20002
    s_add_u32 s62, s62, s63
    s_lshl_b32 s63, s23, 5
    s_add_u32 s63, s63, s22
    s_lshl_b32 s63, s63, 5
    s_add_u32 s63, s63, 33554432
    s_cmp_ge_u32 s24, 4
    s_cbranch_scc1 L2_help
    s_mov_b32 s8, s98
    s_mov_b32 s9, s99
    s_mov_b32 s10, 0x2100000
    s_mov_b32 s11, 0x00020000
    v_mov_b32 v4, 0xdddddddd
    v_bfe_u32 v5, v0, 2, 1
    v_cmp_eq_u32 vcc, 0, v5
    v_mov_b32 v6, 0x3f803f80
    s_nop 0
    v_cndmask_b32 v8, 0, v6, vcc
    v_cndmask_b32 v9, 0, v6, vcc
    v_cndmask_b32 v10, v6, 0, vcc
    v_cndmask_b32 v11, v6, 0, vcc
    s_add_u32 s38, s37, 0x10000
    v_mov_b32 v2, v7
    v_add_u32 v3, 0x10000, v1
    v_mov_b32 v60, 0
    v_mov_b32 v61, 0
    v_mov_b32 v62, 0
    v_mov_b32 v63, 0
    v_mov_b32 v64, 0
    v_mov_b32 v65, 0
    v_mov_b32 v66, 0
    v_mov_b32 v67, 0
    v_mov_b32 v68, 0
    v_mov_b32 v69, 0
    v_mov_b32 v70, 0
    v_mov_b32 v71, 0
    v_mov_b32 v72, 0
    v_mov_b32 v73, 0
    v_mov_b32 v74, 0
    v_mov_b32 v75, 0
    v_mov_b32 v76, 0
    v_mov_b32 v77, 0
    v_mov_b32 v78, 0
    v_mov_b32 v79, 0
    v_mov_b32 v80, 0
    v_mov_b32 v81, 0
    v_mov_b32 v82, 0
    v_mov_b32 v83, 0
    v_mov_b32 v84, 0
    v_mov_b32 v85, 0
    v_mov_b32 v86, 0
    v_mov_b32 v87, 0
    v_mov_b32 v88, 0
    v_mov_b32 v89, 0
    v_mov_b32 v90, 0
    v_mov_b32 v91, 0
    v_mov_b32 v92, 0
    v_mov_b32 v93, 0
    v_mov_b32 v94, 0
    v_mov_b32 v95, 0
    v_mov_b32 v96, 0
    v_mov_b32 v97, 0
    v_mov_b32 v98, 0
    v_mov_b32 v99, 0
    v_mov_b32 v180, 0
    v_mov_b32 v181, 0
    v_mov_b32 v182, 0
    v_mov_b32 v183, 0
    v_mov_b32 v184, 0
    v_mov_b32 v185, 0
    v_mov_b32 v186, 0
    v_mov_b32 v187, 0
    v_mov_b32 v188, 0
    v_mov_b32 v189, 0
    v_mov_b32 v190, 0
    v_mov_b32 v191, 0
    v_mov_b32 v192, 0
    v_mov_b32 v193, 0
    v_mov_b32 v194, 0
    v_mov_b32 v195, 0
    v_mov_b32 v124, 0
    v_mov_b32 v125, 0
    v_mov_b32 v126, 0
    v_mov_b32 v127, 0
    v_mov_b32 v128, 0
    v_mov_b32 v129, 0
    v_mov_b32 v130, 0
    v_mov_b32 v131, 0
    s_mov_b32 s39, 0
    s_mov_b32 s40, 0
    s_waitcnt lgkmcnt(0)
    s_cmp_lg_u32 s60, 0
    s_cbranch_scc1 L2_x1
    s_waitcnt vmcnt(0)
L2_x1:
    s_barrier
    s_barrier
    buffer_load_dwordx4 v[12:15], v1, s[8:11], s27 offen offset:0 sc1
    buffer_load_dwordx4 v[100:103], v7, s[8:11], s33 offen offset:0 sc1
    buffer_load_dwordx4 v[16:19], v1, s[8:11], s27 offen offset:1024 sc1
    buffer_load_dwordx4 v[104:107], v7, s[8:11], s33 offen offset:1024 sc1
    buffer_load_dwordx4 v[20:23], v1, s[8:11], s27 offen offset:2048 sc1
    buffer_load_dwordx4 v[24:27], v1, s[8:11], s27 offen offset:3072 sc1
    buffer_load_dwordx4 v[108:111], v7, s[8:11], s33 offen offset:2048 sc1
    buffer_load_dwordx4 v[112:115], v7, s[8:11], s33 offen offset:3072 sc1
    s_waitcnt vmcnt(4)
    v_mfma_f32_32x32x16_bf16 v[132:147], v[100:103], v[12:15], 0
    v_mfma_f32_32x32x16_bf16 v[132:147], v[104:107], v[16:19], v[132:147]
    s_waitcnt vmcnt(2)
    v_mfma_f32_32x32x16_bf16 v[148:163], v[100:103], v[20:23], 0
    v_mfma_f32_32x32x16_bf16 v[148:163], v[104:107], v[24:27], v[148:163]
    s_nop 8
    v_max3_f32 v5, v132, v133, v134
    v_max3_f32 v6, v135, v136, v137
    v_max3_f32 v5, v5, v138, v139
    v_max3_f32 v6, v6, v140, v141
    v_max3_f32 v5, v5, v142, v143
    v_max3_f32 v6, v6, v144, v145
    v_max3_f32 v5, v5, v146, v147
    v_max_f32 v5, v5, v6
    s_nop 0
    v_mov_b32 v6, v5
    s_nop 1
    v_permlane32_swap_b32 v5, v6
    s_nop 1
    v_max_f32 v5, v5, v6
    v_sub_f32 v28, 0, v5
    v_sub_f32 v29, 0, v5
    v_sub_f32 v30, 0, v5
    v_sub_f32 v31, 0, v5
    v_sub_f32 v32, 0, v5
    v_sub_f32 v33, 0, v5
    v_sub_f32 v34, 0, v5
    v_sub_f32 v35, 0, v5
    v_sub_f32 v36, 0, v5
    v_sub_f32 v37, 0, v5
    v_sub_f32 v38, 0, v5
    v_sub_f32 v39, 0, v5
    v_sub_f32 v40, 0, v5
    v_sub_f32 v41, 0, v5
    v_sub_f32 v42, 0, v5
    v_sub_f32 v43, 0, v5
    v_sub_f32 v132, v132, v5
    v_sub_f32 v133, v133, v5
    v_sub_f32 v134, v134, v5
    v_sub_f32 v135, v135, v5
    v_sub_f32 v136, v136, v5
    v_sub_f32 v137, v137, v5
    v_sub_f32 v138, v138, v5
    v_sub_f32 v139, v139, v5
    v_sub_f32 v140, v140, v5
    v_sub_f32 v141, v141, v5
    v_sub_f32 v142, v142, v5
    v_sub_f32 v143, v143, v5
    v_sub_f32 v144, v144, v5
    v_sub_f32 v145, v145, v5
    v_sub_f32 v146, v146, v5
    v_sub_f32 v147, v147, v5
    v_max3_f32 v5, v148, v149, v150
    v_max3_f32 v6, v151, v152, v153
    v_max3_f32 v5, v5, v154, v155
    v_max3_f32 v6, v6, v156, v157
    v_max3_f32 v5, v5, v158, v159
    v_max3_f32 v6, v6, v160, v161
    v_max3_f32 v5, v5, v162, v163
    v_max_f32 v5, v5, v6
    s_nop 0
    v_mov_b32 v6, v5
    s_nop 1
    v_permlane32_swap_b32 v5, v6
    s_nop 1
    v_max_f32 v5, v5, v6
    v_sub_f32 v44, 0, v5
    v_sub_f32 v45, 0, v5
    v_sub_f32 v46, 0, v5
    v_sub_f32 v47, 0, v5
    v_sub_f32 v48, 0, v5
    v_sub_f32 v49, 0, v5
    v_sub_f32 v50, 0, v5
    v_sub_f32 v51, 0, v5
    v_sub_f32 v52, 0, v5
    v_sub_f32 v53, 0, v5
    v_sub_f32 v54, 0, v5
    v_sub_f32 v55, 0, v5
    v_sub_f32 v56, 0, v5
    v_sub_f32 v57, 0, v5
    v_sub_f32 v58, 0, v5
    v_sub_f32 v59, 0, v5
    s_waitcnt vmcnt(0)
    s_barrier
    buffer_load_dword v196, v1, s[8:11], s37 offen
    s_setprio 2
    s_cmp_eq_u32 s60, 0
    s_cbranch_scc1 L2_it3
    buffer_store_dwordx4 v[240:243], v200, s[8:11], s94 offen offset:0 sc1
    buffer_store_dwordx4 v[244:247], v200, s[8:11], s94 offen offset:256 sc1
    buffer_store_dwordx4 v[248:251], v200, s[8:11], s94 offen offset:2048 sc1
    buffer_store_dwordx4 v[252:255], v200, s[8:11], s94 offen offset:2304 sc1
    s_branch L2_it3
.p2align 6
L2_loop:
    v_mfma_f32_32x32x16_bf16 v[164:179], v[108:111], v[12:15], v[28:43]
    v_exp_f32 v148, v148
    v_exp_f32 v149, v149
    v_exp_f32 v150, v150
    v_mfma_f32_32x32x16_bf16 v[164:179], v[112:115], v[16:19], v[164:179]
    s_waitcnt lgkmcnt(0)
    s_waitcnt vmcnt(0)
    s_barrier
    v_add_u32 v2, s40, v7
    v_exp_f32 v151, v151
    v_exp_f32 v152, v152
    v_exp_f32 v153, v153
    v_smfmac_f32_32x32x32_bf16 v[60:75], v[116:119], v[132:139], v4
    ds_read_b128 v[100:103], v2 offset:0
    v_exp_f32 v154, v154
    v_exp_f32 v155, v155
    v_exp_f32 v156, v156
    v_smfmac_f32_16x16x64_bf16 v[92:95], v[8:11], v[132:139], v4
    v_exp_f32 v157, v157
    v_smfmac_f32_32x32x32_bf16 v[60:75], v[120:123], v[140:147], v4
    ds_read_b128 v[104:107], v2 offset:1024
    v_exp_f32 v158, v158
    v_exp_f32 v159, v159
    v_exp_f32 v160, v160
    v_smfmac_f32_16x16x64_bf16 v[92:95], v[8:11], v[140:147], v4
    v_exp_f32 v161, v161
    v_exp_f32 v162, v162
    v_exp_f32 v163, v163
    v_mfma_f32_32x32x16_bf16 v[180:195], v[108:111], v[20:23], v[44:59]
    v_exp_f32 v164, v164
    v_exp_f32 v165, v165
    v_exp_f32 v166, v166
    v_mfma_f32_32x32x16_bf16 v[180:195], v[112:115], v[24:27], v[180:195]
    s_waitcnt lgkmcnt(0)
    v_exp_f32 v167, v167
    v_exp_f32 v168, v168
    v_exp_f32 v169, v169
    v_smfmac_f32_32x32x32_bf16 v[76:91], v[116:119], v[148:155], v4
    ds_read_b128 v[124:127], v3 offset:14336
    v_exp_f32 v170, v170
    v_exp_f32 v171, v171
    v_exp_f32 v172, v172
    v_smfmac_f32_16x16x64_bf16 v[96:99], v[8:11], v[148:155], v4
    v_exp_f32 v173, v173
    v_smfmac_f32_32x32x32_bf16 v[76:91], v[120:123], v[156:163], v4
    ds_read_b128 v[128:131], v3 offset:15360
    v_exp_f32 v174, v174
    v_exp_f32 v175, v175
    v_exp_f32 v176, v176
    v_smfmac_f32_16x16x64_bf16 v[96:99], v[8:11], v[156:163], v4
    v_exp_f32 v177, v177
    v_exp_f32 v178, v178
    v_exp_f32 v179, v179
    v_mfma_f32_32x32x16_bf16 v[132:147], v[100:103], v[12:15], v[28:43]
    v_exp_f32 v180, v180
    v_exp_f32 v181, v181
    v_exp_f32 v182, v182
    v_mfma_f32_32x32x16_bf16 v[132:147], v[104:107], v[16:19], v[132:147]
    s_waitcnt lgkmcnt(0)
    v_exp_f32 v183, v183
    v_exp_f32 v184, v184
    v_exp_f32 v185, v185
    v_smfmac_f32_32x32x32_bf16 v[60:75], v[124:127], v[164:171], v4
    ds_read_b128 v[108:111], v2 offset:2048
    v_exp_f32 v186, v186
    v_exp_f32 v187, v187
    v_exp_f32 v188, v188
    v_smfmac_f32_16x16x64_bf16 v[92:95], v[8:11], v[164:171], v4
    v_exp_f32 v189, v189
    v_smfmac_f32_32x32x32_bf16 v[60:75], v[128:131], v[172:179], v4
    ds_read_b128 v[112:115], v2 offset:3072
    v_exp_f32 v190, v190
    v_exp_f32 v191, v191
    v_exp_f32 v192, v192
    v_smfmac_f32_16x16x64_bf16 v[92:95], v[8:11], v[172:179], v4
    v_exp_f32 v193, v193
    v_exp_f32 v194, v194
    v_exp_f32 v195, v195
    v_add_u32 v3, s41, v1
L2_it3:
    v_mfma_f32_32x32x16_bf16 v[148:163], v[100:103], v[20:23], v[44:59]
    v_exp_f32 v132, v132
    v_exp_f32 v133, v133
    v_exp_f32 v134, v134
    v_mfma_f32_32x32x16_bf16 v[148:163], v[104:107], v[24:27], v[148:163]
    s_waitcnt lgkmcnt(0)
    v_exp_f32 v135, v135
    v_exp_f32 v136, v136
    v_exp_f32 v137, v137
    v_smfmac_f32_32x32x32_bf16 v[76:91], v[124:127], v[180:187], v4
    ds_read_b128 v[116:119], v3 offset:0
    v_exp_f32 v138, v138
    v_exp_f32 v139, v139
    v_exp_f32 v140, v140
    v_smfmac_f32_16x16x64_bf16 v[96:99], v[8:11], v[180:187], v4
    v_exp_f32 v141, v141
    v_smfmac_f32_32x32x32_bf16 v[76:91], v[128:131], v[188:195], v4
    ds_read_b128 v[120:123], v3 offset:1024
    v_exp_f32 v142, v142
    v_exp_f32 v143, v143
    v_exp_f32 v144, v144
    v_smfmac_f32_16x16x64_bf16 v[96:99], v[8:11], v[188:195], v4
    v_exp_f32 v145, v145
    v_exp_f32 v146, v146
    v_exp_f32 v147, v147
    v_mfma_f32_32x32x16_bf16 v[164:179], v[108:111], v[12:15], v[28:43]
    v_exp_f32 v148, v148
    v_exp_f32 v149, v149
    v_exp_f32 v150, v150
    v_mfma_f32_32x32x16_bf16 v[164:179], v[112:115], v[16:19], v[164:179]
    s_waitcnt lgkmcnt(0)
    v_exp_f32 v151, v151
    v_exp_f32 v152, v152
    v_exp_f32 v153, v153
    v_smfmac_f32_32x32x32_bf16 v[60:75], v[116:119], v[132:139], v4
    ds_read_b128 v[100:103], v2 offset:4096
    v_exp_f32 v154, v154
    v_exp_f32 v155, v155
    v_exp_f32 v156, v156
    v_smfmac_f32_16x16x64_bf16 v[92:95], v[8:11], v[132:139], v4
    v_exp_f32 v157, v157
    v_smfmac_f32_32x32x32_bf16 v[60:75], v[120:123], v[140:147], v4
    ds_read_b128 v[104:107], v2 offset:5120
    v_exp_f32 v158, v158
    v_exp_f32 v159, v159
    v_exp_f32 v160, v160
    v_smfmac_f32_16x16x64_bf16 v[92:95], v[8:11], v[140:147], v4
    v_exp_f32 v161, v161
    v_exp_f32 v162, v162
    v_exp_f32 v163, v163
    v_mfma_f32_32x32x16_bf16 v[180:195], v[108:111], v[20:23], v[44:59]
    v_exp_f32 v164, v164
    v_exp_f32 v165, v165
    v_exp_f32 v166, v166
    v_mfma_f32_32x32x16_bf16 v[180:195], v[112:115], v[24:27], v[180:195]
    s_waitcnt lgkmcnt(0)
    v_exp_f32 v167, v167
    v_exp_f32 v168, v168
    v_exp_f32 v169, v169
    v_smfmac_f32_32x32x32_bf16 v[76:91], v[116:119], v[148:155], v4
    ds_read_b128 v[124:127], v3 offset:2048
    v_exp_f32 v170, v170
    v_exp_f32 v171, v171
    v_exp_f32 v172, v172
    v_smfmac_f32_16x16x64_bf16 v[96:99], v[8:11], v[148:155], v4
    v_exp_f32 v173, v173
    v_smfmac_f32_32x32x32_bf16 v[76:91], v[120:123], v[156:163], v4
    ds_read_b128 v[128:131], v3 offset:3072
    v_exp_f32 v174, v174
    v_exp_f32 v175, v175
    v_exp_f32 v176, v176
    v_smfmac_f32_16x16x64_bf16 v[96:99], v[8:11], v[156:163], v4
    v_exp_f32 v177, v177
    v_exp_f32 v178, v178
    v_exp_f32 v179, v179
    v_mfma_f32_32x32x16_bf16 v[132:147], v[100:103], v[12:15], v[28:43]
    v_exp_f32 v180, v180
    v_exp_f32 v181, v181
    v_exp_f32 v182, v182
    v_mfma_f32_32x32x16_bf16 v[132:147], v[104:107], v[16:19], v[132:147]
    s_waitcnt lgkmcnt(0)
    v_exp_f32 v183, v183
    v_exp_f32 v184, v184
    v_exp_f32 v185, v185
    v_smfmac_f32_32x32x32_bf16 v[60:75], v[124:127], v[164:171], v4
    ds_read_b128 v[108:111], v2 offset:6144
    v_exp_f32 v186, v186
    v_exp_f32 v187, v187
    v_exp_f32 v188, v188
    v_smfmac_f32_16x16x64_bf16 v[92:95], v[8:11], v[164:171], v4
    v_exp_f32 v189, v189
    v_smfmac_f32_32x32x32_bf16 v[60:75], v[128:131], v[172:179], v4
    ds_read_b128 v[112:115], v2 offset:7168
    v_exp_f32 v190, v190
    v_exp_f32 v191, v191
    v_exp_f32 v192, v192
    v_smfmac_f32_16x16x64_bf16 v[92:95], v[8:11], v[172:179], v4
    v_exp_f32 v193, v193
    v_exp_f32 v194, v194
    v_exp_f32 v195, v195
    v_mfma_f32_32x32x16_bf16 v[148:163], v[100:103], v[20:23], v[44:59]
    v_exp_f32 v132, v132
    v_exp_f32 v133, v133
    v_exp_f32 v134, v134
    v_mfma_f32_32x32x16_bf16 v[148:163], v[104:107], v[24:27], v[148:163]
    s_waitcnt lgkmcnt(0)
    v_exp_f32 v135, v135
    v_exp_f32 v136, v136
    v_exp_f32 v137, v137
    v_smfmac_f32_32x32x32_bf16 v[76:91], v[124:127], v[180:187], v4
    ds_read_b128 v[116:119], v3 offset:4096
    v_exp_f32 v138, v138
    v_exp_f32 v139, v139
    v_exp_f32 v140, v140
    v_smfmac_f32_16x16x64_bf16 v[96:99], v[8:11], v[180:187], v4
    v_exp_f32 v141, v141
    v_smfmac_f32_32x32x32_bf16 v[76:91], v[128:131], v[188:195], v4
    ds_read_b128 v[120:123], v3 offset:5120
    v_exp_f32 v142, v142
    v_exp_f32 v143, v143
    v_exp_f32 v144, v144
    v_smfmac_f32_16x16x64_bf16 v[96:99], v[8:11], v[188:195], v4
    v_exp_f32 v145, v145
    v_exp_f32 v146, v146
    v_exp_f32 v147, v147
    v_mfma_f32_32x32x16_bf16 v[164:179], v[108:111], v[12:15], v[28:43]
    v_exp_f32 v148, v148
    v_exp_f32 v149, v149
    v_exp_f32 v150, v150
    v_mfma_f32_32x32x16_bf16 v[164:179], v[112:115], v[16:19], v[164:179]
    s_waitcnt lgkmcnt(0)
    v_exp_f32 v151, v151
    v_exp_f32 v152, v152
    v_exp_f32 v153, v153
    v_smfmac_f32_32x32x32_bf16 v[60:75], v[116:119], v[132:139], v4
    ds_read_b128 v[100:103], v2 offset:8192
    v_exp_f32 v154, v154
    v_exp_f32 v155, v155
    v_exp_f32 v156, v156
    v_smfmac_f32_16x16x64_bf16 v[92:95], v[8:11], v[132:139], v4
    v_exp_f32 v157, v157
    v_smfmac_f32_32x32x32_bf16 v[60:75], v[120:123], v[140:147], v4
    ds_read_b128 v[104:107], v2 offset:9216
    v_exp_f32 v158, v158
    v_exp_f32 v159, v159
    v_exp_f32 v160, v160
    v_smfmac_f32_16x16x64_bf16 v[92:95], v[8:11], v[140:147], v4
    v_exp_f32 v161, v161
    v_exp_f32 v162, v162
    v_exp_f32 v163, v163
    v_mfma_f32_32x32x16_bf16 v[180:195], v[108:111], v[20:23], v[44:59]
    v_exp_f32 v164, v164
    v_exp_f32 v165, v165
    v_exp_f32 v166, v166
    v_mfma_f32_32x32x16_bf16 v[180:195], v[112:115], v[24:27], v[180:195]
    s_waitcnt lgkmcnt(0)
    v_exp_f32 v167, v167
    v_exp_f32 v168, v168
    v_exp_f32 v169, v169
    v_smfmac_f32_32x32x32_bf16 v[76:91], v[116:119], v[148:155], v4
    ds_read_b128 v[124:127], v3 offset:6144
    v_exp_f32 v170, v170
    v_exp_f32 v171, v171
    v_exp_f32 v172, v172
    v_smfmac_f32_16x16x64_bf16 v[96:99], v[8:11], v[148:155], v4
    v_exp_f32 v173, v173
    v_smfmac_f32_32x32x32_bf16 v[76:91], v[120:123], v[156:163], v4
    ds_read_b128 v[128:131], v3 offset:7168
    v_exp_f32 v174, v174
    v_exp_f32 v175, v175
    v_exp_f32 v176, v176
    v_smfmac_f32_16x16x64_bf16 v[96:99], v[8:11], v[156:163], v4
    v_exp_f32 v177, v177
    v_exp_f32 v178, v178
    v_exp_f32 v179, v179
    v_mfma_f32_32x32x16_bf16 v[132:147], v[100:103], v[12:15], v[28:43]
    v_exp_f32 v180, v180
    v_exp_f32 v181, v181
    v_exp_f32 v182, v182
    v_mfma_f32_32x32x16_bf16 v[132:147], v[104:107], v[16:19], v[132:147]
    s_waitcnt lgkmcnt(0)
    v_exp_f32 v183, v183
    v_exp_f32 v184, v184
    v_exp_f32 v185, v185
    v_smfmac_f32_32x32x32_bf16 v[60:75], v[124:127], v[164:171], v4
    ds_read_b128 v[108:111], v2 offset:10240
    v_exp_f32 v186, v186
    v_exp_f32 v187, v187
    v_exp_f32 v188, v188
    v_smfmac_f32_16x16x64_bf16 v[92:95], v[8:11], v[164:171], v4
    v_exp_f32 v189, v189
    v_smfmac_f32_32x32x32_bf16 v[60:75], v[128:131], v[172:179], v4
    ds_read_b128 v[112:115], v2 offset:11264
    v_exp_f32 v190, v190
    v_exp_f32 v191, v191
    v_exp_f32 v192, v192
    v_smfmac_f32_16x16x64_bf16 v[92:95], v[8:11], v[172:179], v4
    v_exp_f32 v193, v193
    v_exp_f32 v194, v194
    v_exp_f32 v195, v195
    v_mfma_f32_32x32x16_bf16 v[148:163], v[100:103], v[20:23], v[44:59]
    v_exp_f32 v132, v132
    v_exp_f32 v133, v133
    v_exp_f32 v134, v134
    v_mfma_f32_32x32x16_bf16 v[148:163], v[104:107], v[24:27], v[148:163]
    s_waitcnt lgkmcnt(0)
    v_exp_f32 v135, v135
    v_exp_f32 v136, v136
    v_exp_f32 v137, v137
    v_smfmac_f32_32x32x32_bf16 v[76:91], v[124:127], v[180:187], v4
    ds_read_b128 v[116:119], v3 offset:8192
    v_exp_f32 v138, v138
    v_exp_f32 v139, v139
    v_exp_f32 v140, v140
    v_smfmac_f32_16x16x64_bf16 v[96:99], v[8:11], v[180:187], v4
    v_exp_f32 v141, v141
    v_smfmac_f32_32x32x32_bf16 v[76:91], v[128:131], v[188:195], v4
    ds_read_b128 v[120:123], v3 offset:9216
    v_exp_f32 v142, v142
    v_exp_f32 v143, v143
    v_exp_f32 v144, v144
    v_smfmac_f32_16x16x64_bf16 v[96:99], v[8:11], v[188:195], v4
    v_exp_f32 v145, v145
    v_exp_f32 v146, v146
    v_exp_f32 v147, v147
    v_mfma_f32_32x32x16_bf16 v[164:179], v[108:111], v[12:15], v[28:43]
    v_exp_f32 v148, v148
    v_exp_f32 v149, v149
    v_exp_f32 v150, v150
    v_mfma_f32_32x32x16_bf16 v[164:179], v[112:115], v[16:19], v[164:179]
    s_waitcnt lgkmcnt(0)
    v_exp_f32 v151, v151
    v_exp_f32 v152, v152
    v_exp_f32 v153, v153
    v_smfmac_f32_32x32x32_bf16 v[60:75], v[116:119], v[132:139], v4
    ds_read_b128 v[100:103], v2 offset:12288
    v_exp_f32 v154, v154
    v_exp_f32 v155, v155
    v_exp_f32 v156, v156
    v_smfmac_f32_16x16x64_bf16 v[92:95], v[8:11], v[132:139], v4
    v_exp_f32 v157, v157
    v_smfmac_f32_32x32x32_bf16 v[60:75], v[120:123], v[140:147], v4
    ds_read_b128 v[104:107], v2 offset:13312
    v_exp_f32 v158, v158
    v_exp_f32 v159, v159
    v_exp_f32 v160, v160
    v_smfmac_f32_16x16x64_bf16 v[92:95], v[8:11], v[140:147], v4
    v_exp_f32 v161, v161
    v_exp_f32 v162, v162
    v_exp_f32 v163, v163
    v_mfma_f32_32x32x16_bf16 v[180:195], v[108:111], v[20:23], v[44:59]
    v_exp_f32 v164, v164
    v_exp_f32 v165, v165
    v_exp_f32 v166, v166
    v_mfma_f32_32x32x16_bf16 v[180:195], v[112:115], v[24:27], v[180:195]
    s_waitcnt lgkmcnt(0)
    v_exp_f32 v167, v167
    v_exp_f32 v168, v168
    v_exp_f32 v169, v169
    v_smfmac_f32_32x32x32_bf16 v[76:91], v[116:119], v[148:155], v4
    ds_read_b128 v[124:127], v3 offset:10240
    v_exp_f32 v170, v170
    v_exp_f32 v171, v171
    v_exp_f32 v172, v172
    v_smfmac_f32_16x16x64_bf16 v[96:99], v[8:11], v[148:155], v4
    v_exp_f32 v173, v173
    v_smfmac_f32_32x32x32_bf16 v[76:91], v[120:123], v[156:163], v4
    ds_read_b128 v[128:131], v3 offset:11264
    v_exp_f32 v174, v174
    v_exp_f32 v175, v175
    v_exp_f32 v176, v176
    v_smfmac_f32_16x16x64_bf16 v[96:99], v[8:11], v[156:163], v4
    v_exp_f32 v177, v177
    v_exp_f32 v178, v178
    v_exp_f32 v179, v179
    v_mfma_f32_32x32x16_bf16 v[132:147], v[100:103], v[12:15], v[28:43]
    v_exp_f32 v180, v180
    v_exp_f32 v181, v181
    v_exp_f32 v182, v182
    v_mfma_f32_32x32x16_bf16 v[132:147], v[104:107], v[16:19], v[132:147]
    s_waitcnt lgkmcnt(0)
    v_exp_f32 v183, v183
    v_exp_f32 v184, v184
    v_exp_f32 v185, v185
    v_smfmac_f32_32x32x32_bf16 v[60:75], v[124:127], v[164:171], v4
    ds_read_b128 v[108:111], v2 offset:14336
    v_exp_f32 v186, v186
    v_exp_f32 v187, v187
    v_exp_f32 v188, v188
    v_smfmac_f32_16x16x64_bf16 v[92:95], v[8:11], v[164:171], v4
    v_exp_f32 v189, v189
    v_smfmac_f32_32x32x32_bf16 v[60:75], v[128:131], v[172:179], v4
    ds_read_b128 v[112:115], v2 offset:15360
    v_exp_f32 v190, v190
    v_exp_f32 v191, v191
    v_exp_f32 v192, v192
    v_smfmac_f32_16x16x64_bf16 v[92:95], v[8:11], v[172:179], v4
    v_exp_f32 v193, v193
    v_exp_f32 v194, v194
    v_exp_f32 v195, v195
    v_mfma_f32_32x32x16_bf16 v[148:163], v[100:103], v[20:23], v[44:59]
    s_add_u32 s40, s40, 16384
    v_exp_f32 v132, v132
    v_exp_f32 v133, v133
    v_exp_f32 v134, v134
    v_mfma_f32_32x32x16_bf16 v[148:163], v[104:107], v[24:27], v[148:163]
    s_waitcnt lgkmcnt(0)
    v_exp_f32 v135, v135
    v_exp_f32 v136, v136
    v_exp_f32 v137, v137
    v_smfmac_f32_32x32x32_bf16 v[76:91], v[124:127], v[180:187], v4
    ds_read_b128 v[116:119], v3 offset:12288
    v_exp_f32 v138, v138
    v_exp_f32 v139, v139
    v_exp_f32 v140, v140
    v_smfmac_f32_16x16x64_bf16 v[96:99], v[8:11], v[180:187], v4
    s_and_b32 s40, s40, 0xffff
    s_add_u32 s41, s40, 0x10000
    v_exp_f32 v141, v141
    v_smfmac_f32_32x32x32_bf16 v[76:91], v[128:131], v[188:195], v4
    ds_read_b128 v[120:123], v3 offset:13312
    v_exp_f32 v142, v142
    v_exp_f32 v143, v143
    v_exp_f32 v144, v144
    v_smfmac_f32_16x16x64_bf16 v[96:99], v[8:11], v[188:195], v4
    s_add_u32 s39, s39, 1
    s_cmp_lt_u32 s39, 8
    v_exp_f32 v145, v145
    v_exp_f32 v146, v146
    v_exp_f32 v147, v147
    s_cbranch_scc1 L2_loop
    v_mfma_f32_32x32x16_bf16 v[164:179], v[108:111], v[12:15], v[28:43]
    v_exp_f32 v148, v148
    v_exp_f32 v149, v149
    v_exp_f32 v150, v150
    v_mfma_f32_32x32x16_bf16 v[164:179], v[112:115], v[16:19], v[164:179]
    s_waitcnt lgkmcnt(0)
    v_exp_f32 v151, v151
    v_exp_f32 v152, v152
    v_exp_f32 v153, v153
    v_smfmac_f32_32x32x32_bf16 v[60:75], v[116:119], v[132:139], v4
    v_exp_f32 v154, v154
    v_exp_f32 v155, v155
    v_exp_f32 v156, v156
    v_smfmac_f32_16x16x64_bf16 v[92:95], v[8:11], v[132:139], v4
    v_exp_f32 v157, v157
    v_smfmac_f32_32x32x32_bf16 v[60:75], v[120:123], v[140:147], v4
    v_exp_f32 v158, v158
    v_exp_f32 v159, v159
    v_exp_f32 v160, v160
    v_smfmac_f32_16x16x64_bf16 v[92:95], v[8:11], v[140:147], v4
    v_exp_f32 v161, v161
    v_exp_f32 v162, v162
    v_exp_f32 v163, v163
    v_mfma_f32_32x32x16_bf16 v[180:195], v[108:111], v[20:23], v[44:59]
    v_exp_f32 v164, v164
    v_exp_f32 v165, v165
    v_exp_f32 v166, v166
    v_mfma_f32_32x32x16_bf16 v[180:195], v[112:115], v[24:27], v[180:195]
    s_waitcnt lgkmcnt(0)
    v_exp_f32 v167, v167
    v_exp_f32 v168, v168
    v_exp_f32 v169, v169
    v_smfmac_f32_32x32x32_bf16 v[76:91], v[116:119], v[148:155], v4
    ds_read_b128 v[124:127], v3 offset:14336
    v_exp_f32 v170, v170
    v_exp_f32 v171, v171
    v_exp_f32 v172, v172
    v_smfmac_f32_16x16x64_bf16 v[96:99], v[8:11], v[148:155], v4
    v_exp_f32 v173, v173
    v_smfmac_f32_32x32x32_bf16 v[76:91], v[120:123], v[156:163], v4
    ds_read_b128 v[128:131], v3 offset:15360
    v_exp_f32 v174, v174
    v_exp_f32 v175, v175
    v_exp_f32 v176, v176
    v_smfmac_f32_16x16x64_bf16 v[96:99], v[8:11], v[156:163], v4
    v_exp_f32 v177, v177
    v_exp_f32 v178, v178
    v_exp_f32 v179, v179
    v_exp_f32 v180, v180
    v_exp_f32 v181, v181
    v_exp_f32 v182, v182
    s_waitcnt lgkmcnt(0)
    v_exp_f32 v183, v183
    v_exp_f32 v184, v184
    v_exp_f32 v185, v185
    v_smfmac_f32_32x32x32_bf16 v[60:75], v[124:127], v[164:171], v4
    v_exp_f32 v186, v186
    v_exp_f32 v187, v187
    v_exp_f32 v188, v188
    v_smfmac_f32_16x16x64_bf16 v[92:95], v[8:11], v[164:171], v4
    v_exp_f32 v189, v189
    v_smfmac_f32_32x32x32_bf16 v[60:75], v[128:131], v[172:179], v4
    v_exp_f32 v190, v190
    v_exp_f32 v191, v191
    v_exp_f32 v192, v192
    v_smfmac_f32_16x16x64_bf16 v[92:95], v[8:11], v[172:179], v4
    v_exp_f32 v193, v193
    v_exp_f32 v194, v194
    v_exp_f32 v195, v195
    s_nop 1
    v_smfmac_f32_32x32x32_bf16 v[76:91], v[124:127], v[180:187], v4
    v_smfmac_f32_16x16x64_bf16 v[96:99], v[8:11], v[180:187], v4
    v_smfmac_f32_32x32x32_bf16 v[76:91], v[128:131], v[188:195], v4
    v_smfmac_f32_16x16x64_bf16 v[96:99], v[8:11], v[188:195], v4
    s_nop 4
    v_mul_f32 v5, 0, v60
    v_fma_f32 v5, v61, 0, v5
    v_fma_f32 v5, v62, 0, v5
    v_fma_f32 v5, v63, 0, v5
    v_fma_f32 v5, v64, 0, v5
    v_fma_f32 v5, v65, 0, v5
    v_fma_f32 v5, v66, 0, v5
    v_fma_f32 v5, v67, 0, v5
    v_fma_f32 v5, v68, 0, v5
    v_fma_f32 v5, v69, 0, v5
    v_fma_f32 v5, v70, 0, v5
    v_fma_f32 v5, v71, 0, v5
    v_fma_f32 v5, v72, 0, v5
    v_fma_f32 v5, v73, 0, v5
    v_fma_f32 v5, v74, 0, v5
    v_fma_f32 v5, v75, 0, v5
    v_add_f32 v5, v5, v92
    v_mov_b32 v6, 0x5f800000
    v_cmp_nlt_f32 vcc, v5, v6
    s_nop 4
    s_cbranch_vccnz L2_slow0
L2_fin0:
    v_rcp_f32 v6, v92
    s_nop 0
    v_mul_f32 v60, v60, v6
    v_mul_f32 v61, v61, v6
    v_mul_f32 v62, v62, v6
    v_mul_f32 v63, v63, v6
    v_mul_f32 v64, v64, v6
    v_mul_f32 v65, v65, v6
    v_mul_f32 v66, v66, v6
    v_mul_f32 v67, v67, v6
    v_mul_f32 v68, v68, v6
    v_mul_f32 v69, v69, v6
    v_mul_f32 v70, v70, v6
    v_mul_f32 v71, v71, v6
    v_mul_f32 v72, v72, v6
    v_mul_f32 v73, v73, v6
    v_mul_f32 v74, v74, v6
    v_mul_f32 v75, v75, v6
    v_cvt_pk_bf16_f32 v148, v60, v61
    v_cvt_pk_bf16_f32 v149, v62, v63
    v_cvt_pk_bf16_f32 v150, v64, v65
    v_cvt_pk_bf16_f32 v151, v66, v67
    v_cvt_pk_bf16_f32 v152, v68, v69
    v_cvt_pk_bf16_f32 v153, v70, v71
    v_cvt_pk_bf16_f32 v154, v72, v73
    v_cvt_pk_bf16_f32 v155, v74, v75
    buffer_store_dwordx4 v[148:151], v1, s[8:11], s37 offen sc1
    buffer_store_dwordx4 v[152:155], v1, s[8:11], s37 offen offset:1024 sc1
    v_mul_f32 v5, 0, v76
    v_fma_f32 v5, v77, 0, v5
    v_fma_f32 v5, v78, 0, v5
    v_fma_f32 v5, v79, 0, v5
    v_fma_f32 v5, v80, 0, v5
    v_fma_f32 v5, v81, 0, v5
    v_fma_f32 v5, v82, 0, v5
    v_fma_f32 v5, v83, 0, v5
    v_fma_f32 v5, v84, 0, v5
    v_fma_f32 v5, v85, 0, v5
    v_fma_f32 v5, v86, 0, v5
    v_fma_f32 v5, v87, 0, v5
    v_fma_f32 v5, v88, 0, v5
    v_fma_f32 v5, v89, 0, v5
    v_fma_f32 v5, v90, 0, v5
    v_fma_f32 v5, v91, 0, v5
    v_add_f32 v5, v5, v96
    v_mov_b32 v6, 0x5f800000
    v_cmp_nlt_f32 vcc, v5, v6
    s_nop 4
    s_cbranch_vccnz L2_slow1
L2_fin1:
    v_rcp_f32 v6, v96
    s_nop 0
    v_mul_f32 v76, v76, v6
    v_mul_f32 v77, v77, v6
    v_mul_f32 v78, v78, v6
    v_mul_f32 v79, v79, v6
    v_mul_f32 v80, v80, v6
    v_mul_f32 v81, v81, v6
    v_mul_f32 v82, v82, v6
    v_mul_f32 v83, v83, v6
    v_mul_f32 v84, v84, v6
    v_mul_f32 v85, v85, v6
    v_mul_f32 v86, v86, v6
    v_mul_f32 v87, v87, v6
    v_mul_f32 v88, v88, v6
    v_mul_f32 v89, v89, v6
    v_mul_f32 v90, v90, v6
    v_mul_f32 v91, v91, v6
    v_cvt_pk_bf16_f32 v164, v76, v77
    v_cvt_pk_bf16_f32 v165, v78, v79
    v_cvt_pk_bf16_f32 v166, v80, v81
    v_cvt_pk_bf16_f32 v167, v82, v83
    v_cvt_pk_bf16_f32 v168, v84, v85
    v_cvt_pk_bf16_f32 v169, v86, v87
    v_cvt_pk_bf16_f32 v170, v88, v89
    v_cvt_pk_bf16_f32 v171, v90, v91
    buffer_store_dwordx4 v[164:167], v1, s[8:11], s38 offen sc1
    buffer_store_dwordx4 v[168:171], v1, s[8:11], s38 offen offset:1024 sc1
    s_and_b32 s31, s24, 1
    s_lshr_b32 s32, s24, 1
    v_and_b32 v2, 15, v0
    v_lshrrev_b32 v3, 4, v0
    s_lshl_b32 s33, s31, 13
    v_lshlrev_b32 v4, 4, v2
    v_lshl_add_u32 v4, v3, 9, v4
    v_add_u32 v10, s33, v4
    v_add_u32 v11, 131072, v10
    v_bfe_u32 v4, v0, 2, 3
    v_lshrrev_b32 v5, 5, v0
    v_lshl_add_u32 v5, v5, 4, v4
    v_lshlrev_b32 v5, 8, v5
    v_and_b32 v6, 3, v0
    v_lshl_add_u32 v5, v6, 3, v5
    v_add_u32 v5, 16384, v5
    s_lshl_b32 s33, s32, 2
    v_xor_b32 v4, s33, v4
    v_lshl_add_u32 v12, v4, 5, v5
    v_xor_b32 v13, 32, v12
    v_xor_b32 v14, 64, v12
    v_xor_b32 v15, 96, v12
    v_add_u32 v16, 131072, v12
    v_add_u32 v17, 131072, v13
    v_add_u32 v18, 131072, v14
    v_add_u32 v19, 131072, v15
    v_mov_b32 v88, 0
    v_mov_b32 v89, 0
    v_mov_b32 v90, 0
    v_mov_b32 v91, 0
    v_mov_b32 v92, 0
    v_mov_b32 v93, 0
    v_mov_b32 v94, 0
    v_mov_b32 v95, 0
    v_mov_b32 v96, 0
    v_mov_b32 v97, 0
    v_mov_b32 v98, 0
    v_mov_b32 v99, 0
    v_mov_b32 v100, 0
    v_mov_b32 v101, 0
    v_mov_b32 v102, 0
    v_mov_b32 v103, 0
    v_mov_b32 v104, 0
    v_mov_b32 v105, 0
    v_mov_b32 v106, 0
    v_mov_b32 v107, 0
    v_mov_b32 v108, 0
    v_mov_b32 v109, 0
    v_mov_b32 v110, 0
    v_mov_b32 v111, 0
    v_mov_b32 v112, 0
    v_mov_b32 v113, 0
    v_mov_b32 v114, 0
    v_mov_b32 v115, 0
    v_mov_b32 v116, 0
    v_mov_b32 v117, 0
    v_mov_b32 v118, 0
    v_mov_b32 v119, 0
    v_mov_b32 v120, 0
    v_mov_b32 v121, 0
    v_mov_b32 v122, 0
    v_mov_b32 v123, 0
    v_mov_b32 v124, 0
    v_mov_b32 v125, 0
    v_mov_b32 v126, 0
    v_mov_b32 v127, 0
    v_mov_b32 v128, 0
    v_mov_b32 v129, 0
    v_mov_b32 v130, 0
    v_mov_b32 v131, 0
    v_mov_b32 v132, 0
    v_mov_b32 v133, 0
    v_mov_b32 v134, 0
    v_mov_b32 v135, 0
    v_mov_b32 v136, 0
    v_mov_b32 v137, 0
    v_mov_b32 v138, 0
    v_mov_b32 v139, 0
    v_mov_b32 v140, 0
    v_mov_b32 v141, 0
    v_mov_b32 v142, 0
    v_mov_b32 v143, 0
    v_mov_b32 v144, 0
    v_mov_b32 v145, 0
    v_mov_b32 v146, 0
    v_mov_b32 v147, 0
    v_mov_b32 v148, 0
    v_mov_b32 v149, 0
    v_mov_b32 v150, 0
    v_mov_b32 v151, 0
    s_mov_b32 s44, 0
    s_mov_b32 s45, 65536
    s_mov_b32 s46, 32768
    s_mov_b32 s47, 98304
    s_mov_b32 s48, 131072
    s_mov_b32 s35, 0
    s_mov_b32 s16, s58
    s_mov_b32 s17, s59
    s_mov_b32 s18, 0x800000
    s_mov_b32 s19, 0x00020000
    s_lshl_b32 s40, s61, 19
    s_lshl_b32 s41, s31, 18
    s_add_u32 s40, s40, s41
    s_lshl_b32 s41, s60, 11
    s_add_u32 s40, s40, s41
    s_lshl_b32 s41, s62, 8
    s_add_u32 s40, s40, s41
    s_lshl_b32 s41, s32, 7
    s_add_u32 s40, s40, s41
    s_waitcnt vmcnt(0)
    s_barrier
    s_barrier
    s_barrier
    ds_read_b128 v[24:27], v11 offset:0
    ds_read_b64_tr_b16 v[40:41], v16 offset:0
    ds_read_b64_tr_b16 v[42:43], v16 offset:2048
    ds_read_b64_tr_b16 v[44:45], v17 offset:0
    ds_read_b64_tr_b16 v[46:47], v17 offset:2048
    ds_read_b64_tr_b16 v[48:49], v18 offset:0
    ds_read_b64_tr_b16 v[50:51], v18 offset:2048
    ds_read_b64_tr_b16 v[52:53], v19 offset:0
    ds_read_b64_tr_b16 v[54:55], v19 offset:2048
    ds_read_b128 v[28:31], v11 offset:256
    ds_read_b128 v[32:35], v11 offset:4096
    ds_read_b128 v[36:39], v11 offset:4352
    s_branch L3_mid
.p2align 6
L3_loop:
    s_waitcnt lgkmcnt(3)
    v_mfma_f32_16x16x32_bf16 v[88:91], v[72:75], v[56:59], v[88:91]
    ds_read_b128 v[24:27], v11 offset:0
    v_mfma_f32_16x16x32_bf16 v[92:95], v[76:79], v[56:59], v[92:95]
    ds_read_b64_tr_b16 v[40:41], v16 offset:0
    v_mfma_f32_16x16x32_bf16 v[96:99], v[80:83], v[56:59], v[96:99]
    ds_read_b64_tr_b16 v[42:43], v16 offset:2048
    v_mfma_f32_16x16x32_bf16 v[100:103], v[84:87], v[56:59], v[100:103]
    ds_read_b64_tr_b16 v[44:45], v17 offset:0
    s_waitcnt lgkmcnt(6)
    v_mfma_f32_16x16x32_bf16 v[104:107], v[72:75], v[60:63], v[104:107]
    ds_read_b64_tr_b16 v[46:47], v17 offset:2048
    v_mfma_f32_16x16x32_bf16 v[108:111], v[76:79], v[60:63], v[108:111]
    ds_read_b64_tr_b16 v[48:49], v18 offset:0
    v_mfma_f32_16x16x32_bf16 v[112:115], v[80:83], v[60:63], v[112:115]
    ds_read_b64_tr_b16 v[50:51], v18 offset:2048
    v_mfma_f32_16x16x32_bf16 v[116:119], v[84:87], v[60:63], v[116:119]
    ds_read_b64_tr_b16 v[52:53], v19 offset:0
    s_waitcnt lgkmcnt(9)
    v_mfma_f32_16x16x32_bf16 v[120:123], v[72:75], v[64:67], v[120:123]
    ds_read_b64_tr_b16 v[54:55], v19 offset:2048
    v_mfma_f32_16x16x32_bf16 v[124:127], v[76:79], v[64:67], v[124:127]
    ds_read_b128 v[28:31], v11 offset:256
    v_mfma_f32_16x16x32_bf16 v[128:131], v[80:83], v[64:67], v[128:131]
    ds_read_b128 v[32:35], v11 offset:4096
    v_mfma_f32_16x16x32_bf16 v[132:135], v[84:87], v[64:67], v[132:135]
    ds_read_b128 v[36:39], v11 offset:4352
    s_waitcnt lgkmcnt(12)
    v_mfma_f32_16x16x32_bf16 v[136:139], v[72:75], v[68:71], v[136:139]
    v_mfma_f32_16x16x32_bf16 v[140:143], v[76:79], v[68:71], v[140:143]
    v_mfma_f32_16x16x32_bf16 v[144:147], v[80:83], v[68:71], v[144:147]
    v_mfma_f32_16x16x32_bf16 v[148:151], v[84:87], v[68:71], v[148:151]
L3_mid:
    s_waitcnt lgkmcnt(3)
    v_mfma_f32_16x16x32_bf16 v[88:91], v[40:43], v[24:27], v[88:91]
    ds_read_b128 v[56:59], v11 offset:2048
    s_mov_b32 s33, s44
    v_mfma_f32_16x16x32_bf16 v[92:95], v[44:47], v[24:27], v[92:95]
    ds_read_b64_tr_b16 v[72:73], v16 offset:8192
    s_mov_b32 s44, s45
    s_mov_b32 s45, s46
    v_mfma_f32_16x16x32_bf16 v[96:99], v[48:51], v[24:27], v[96:99]
    ds_read_b64_tr_b16 v[74:75], v16 offset:10240
    s_mov_b32 s46, s47
    s_mov_b32 s47, s48
    v_mfma_f32_16x16x32_bf16 v[100:103], v[52:55], v[24:27], v[100:103]
    ds_read_b64_tr_b16 v[76:77], v17 offset:8192
    s_mov_b32 s48, s33
    s_waitcnt lgkmcnt(6)
    v_mfma_f32_16x16x32_bf16 v[104:107], v[40:43], v[28:31], v[104:107]
    ds_read_b64_tr_b16 v[78:79], v17 offset:10240
    v_mfma_f32_16x16x32_bf16 v[108:111], v[44:47], v[28:31], v[108:111]
    ds_read_b64_tr_b16 v[80:81], v18 offset:8192
    s_add_u32 s35, s35, 1
    s_cmp_lt_u32 s35, 16
    v_mfma_f32_16x16x32_bf16 v[112:115], v[48:51], v[28:31], v[112:115]
    ds_read_b64_tr_b16 v[82:83], v18 offset:10240
    v_mfma_f32_16x16x32_bf16 v[116:119], v[52:55], v[28:31], v[116:119]
    ds_read_b64_tr_b16 v[84:85], v19 offset:8192
    s_waitcnt lgkmcnt(9)
    v_mfma_f32_16x16x32_bf16 v[120:123], v[40:43], v[32:35], v[120:123]
    ds_read_b64_tr_b16 v[86:87], v19 offset:10240
    v_mfma_f32_16x16x32_bf16 v[124:127], v[44:47], v[32:35], v[124:127]
    ds_read_b128 v[60:63], v11 offset:2304
    v_add_u32 v16, s33, v12
    v_mfma_f32_16x16x32_bf16 v[128:131], v[48:51], v[32:35], v[128:131]
    ds_read_b128 v[64:67], v11 offset:6144
    v_add_u32 v17, s33, v13
    v_mfma_f32_16x16x32_bf16 v[132:135], v[52:55], v[32:35], v[132:135]
    ds_read_b128 v[68:71], v11 offset:6400
    v_add_u32 v18, s33, v14
    s_waitcnt lgkmcnt(12)
    v_mfma_f32_16x16x32_bf16 v[136:139], v[40:43], v[36:39], v[136:139]
    v_add_u32 v19, s33, v15
    v_mfma_f32_16x16x32_bf16 v[140:143], v[44:47], v[36:39], v[140:143]
    v_add_u32 v11, s33, v10
    v_mfma_f32_16x16x32_bf16 v[144:147], v[48:51], v[36:39], v[144:147]
    v_mfma_f32_16x16x32_bf16 v[148:151], v[52:55], v[36:39], v[148:151]
    s_waitcnt lgkmcnt(0)
    s_barrier
    s_cbranch_scc1 L3_loop
    s_waitcnt lgkmcnt(3)
    v_mfma_f32_16x16x32_bf16 v[88:91], v[72:75], v[56:59], v[88:91]
    v_mfma_f32_16x16x32_bf16 v[92:95], v[76:79], v[56:59], v[92:95]
    v_mfma_f32_16x16x32_bf16 v[96:99], v[80:83], v[56:59], v[96:99]
    v_mfma_f32_16x16x32_bf16 v[100:103], v[84:87], v[56:59], v[100:103]
    s_waitcnt lgkmcnt(2)
    v_mfma_f32_16x16x32_bf16 v[104:107], v[72:75], v[60:63], v[104:107]
    v_mfma_f32_16x16x32_bf16 v[108:111], v[76:79], v[60:63], v[108:111]
    v_mfma_f32_16x16x32_bf16 v[112:115], v[80:83], v[60:63], v[112:115]
    v_mfma_f32_16x16x32_bf16 v[116:119], v[84:87], v[60:63], v[116:119]
    s_waitcnt lgkmcnt(1)
    v_mfma_f32_16x16x32_bf16 v[120:123], v[72:75], v[64:67], v[120:123]
    v_mfma_f32_16x16x32_bf16 v[124:127], v[76:79], v[64:67], v[124:127]
    v_mfma_f32_16x16x32_bf16 v[128:131], v[80:83], v[64:67], v[128:131]
    v_mfma_f32_16x16x32_bf16 v[132:135], v[84:87], v[64:67], v[132:135]
    s_waitcnt lgkmcnt(0)
    v_mfma_f32_16x16x32_bf16 v[136:139], v[72:75], v[68:71], v[136:139]
    v_mfma_f32_16x16x32_bf16 v[140:143], v[76:79], v[68:71], v[140:143]
    v_mfma_f32_16x16x32_bf16 v[144:147], v[80:83], v[68:71], v[144:147]
    v_mfma_f32_16x16x32_bf16 v[148:151], v[84:87], v[68:71], v[148:151]
    s_mul_i32 s41, s24, 9216
    v_mul_u32_u24 v4, 144, v2
    v_lshl_add_u32 v4, v3, 3, v4
    v_add_u32 v4, s41, v4
    v_lshrrev_b32 v5, 3, v0
    v_mul_u32_u24 v6, 144, v5
    v_and_b32 v7, 7, v0
    v_lshl_add_u32 v6, v7, 4, v6
    v_add_u32 v6, s41, v6
    v_lshlrev_b32 v5, 12, v5
    v_lshl_add_u32 v20, v7, 4, v5
    v_cvt_pk_bf16_f32 v24, v88, v89
    v_cvt_pk_bf16_f32 v25, v90, v91
    ds_write_b64 v4, v[24:25] offset:0
    v_cvt_pk_bf16_f32 v26, v92, v93
    v_cvt_pk_bf16_f32 v27, v94, v95
    ds_write_b64 v4, v[26:27] offset:32
    v_cvt_pk_bf16_f32 v28, v96, v97
    v_cvt_pk_bf16_f32 v29, v98, v99
    ds_write_b64 v4, v[28:29] offset:64
    v_cvt_pk_bf16_f32 v30, v100, v101
    v_cvt_pk_bf16_f32 v31, v102, v103
    ds_write_b64 v4, v[30:31] offset:96
    ds_read_b128 v[56:59], v6 offset:0
    ds_read_b128 v[60:63], v6 offset:1152
    v_cvt_pk_bf16_f32 v32, v104, v105
    v_cvt_pk_bf16_f32 v33, v106, v107
    ds_write_b64 v4, v[32:33] offset:2304
    v_cvt_pk_bf16_f32 v34, v108, v109
    v_cvt_pk_bf16_f32 v35, v110, v111
    ds_write_b64 v4, v[34:35] offset:2336
    v_cvt_pk_bf16_f32 v36, v112, v113
    v_cvt_pk_bf16_f32 v37, v114, v115
    ds_write_b64 v4, v[36:37] offset:2368
    v_cvt_pk_bf16_f32 v38, v116, v117
    v_cvt_pk_bf16_f32 v39, v118, v119
    ds_write_b64 v4, v[38:39] offset:2400
    ds_read_b128 v[64:67], v6 offset:2304
    ds_read_b128 v[68:71], v6 offset:3456
    s_waitcnt lgkmcnt(6)
    buffer_store_dwordx4 v[56:59], v20, s[16:19], s40 offen sc1
    s_add_u32 s40, s40, 32768
    buffer_store_dwordx4 v[60:63], v20, s[16:19], s40 offen sc1
    s_add_u32 s40, s40, 32768
    v_cvt_pk_bf16_f32 v40, v120, v121
    v_cvt_pk_bf16_f32 v41, v122, v123
    ds_write_b64 v4, v[40:41] offset:4608
    v_cvt_pk_bf16_f32 v42, v124, v125
    v_cvt_pk_bf16_f32 v43, v126, v127
    ds_write_b64 v4, v[42:43] offset:4640
    v_cvt_pk_bf16_f32 v44, v128, v129
    v_cvt_pk_bf16_f32 v45, v130, v131
    ds_write_b64 v4, v[44:45] offset:4672
    v_cvt_pk_bf16_f32 v46, v132, v133
    v_cvt_pk_bf16_f32 v47, v134, v135
    ds_write_b64 v4, v[46:47] offset:4704
    ds_read_b128 v[72:75], v6 offset:4608
    ds_read_b128 v[76:79], v6 offset:5760
    s_waitcnt lgkmcnt(6)
    buffer_store_dwordx4 v[64:67], v20, s[16:19], s40 offen sc1
    s_add_u32 s40, s40, 32768
    buffer_store_dwordx4 v[68:71], v20, s[16:19], s40 offen sc1
    s_add_u32 s40, s40, 32768
    v_cvt_pk_bf16_f32 v48, v136, v137
    v_cvt_pk_bf16_f32 v49, v138, v139
    ds_write_b64 v4, v[48:49] offset:6912
    v_cvt_pk_bf16_f32 v50, v140, v141
    v_cvt_pk_bf16_f32 v51, v142, v143
    ds_write_b64 v4, v[50:51] offset:6944
    v_cvt_pk_bf16_f32 v52, v144, v145
    v_cvt_pk_bf16_f32 v53, v146, v147
    ds_write_b64 v4, v[52:53] offset:6976
    v_cvt_pk_bf16_f32 v54, v148, v149
    v_cvt_pk_bf16_f32 v55, v150, v151
    ds_write_b64 v4, v[54:55] offset:7008
    ds_read_b128 v[80:83], v6 offset:6912
    ds_read_b128 v[84:87], v6 offset:8064
    s_waitcnt lgkmcnt(6)
    buffer_store_dwordx4 v[72:75], v20, s[16:19], s40 offen sc1
    s_add_u32 s40, s40, 32768
    buffer_store_dwordx4 v[76:79], v20, s[16:19], s40 offen sc1
    s_add_u32 s40, s40, 32768
    s_waitcnt lgkmcnt(0)
    buffer_store_dwordx4 v[80:83], v20, s[16:19], s40 offen sc1
    s_add_u32 s40, s40, 32768
    buffer_store_dwordx4 v[84:87], v20, s[16:19], s40 offen sc1
    s_add_u32 s40, s40, 32768
L2_end:
    s_endpgm
L2_help:
    s_lshl_b32 s34, s28, 12
    s_add_u32 s35, s33, s34
    s_add_u32 s36, s35, 8388608
    s_mov_b32 s8, s98
    s_mov_b32 s9, s99
    s_mov_b32 s10, 0x2100000
    s_mov_b32 s11, 0x00020000
    v_mov_b32 v203, 0
    v_mov_b32 v204, 1
    v_and_b32 v205, 7, v0
    v_lshlrev_b32 v205, 5, v205
    s_lshr_b32 s84, s22, 1
    s_lshl_b32 s84, s84, 8
    s_add_u32 s84, s84, 33595392
    s_waitcnt vmcnt(0) lgkmcnt(0)
    v_mov_b32 v202, v8
    s_mov_b32 s16, s6
    s_mov_b32 s17, s7
    s_mov_b32 s18, 0x200000
    s_mov_b32 s19, 0x00020000
    s_cmp_eq_u32 s60, 0
    s_cbranch_scc1 L2_hA
    s_cmp_lg_u32 s24, 5
    s_cbranch_scc1 L2B_qx
    v_cmp_gt_u32 vcc, 0x100, v202
    s_nop 4
    s_cbranch_vccz L2B_cx
    s_mov_b32 s43, 0
L2B_c:
    buffer_load_dword v199, v203, s[80:83], 0 offen sc1
    s_add_u32 s43, s43, 1
    s_waitcnt vmcnt(0)
    v_cmp_gt_u32 vcc, 0x100, v199
    s_cmp_gt_u32 s43, 0x200000
    s_cbranch_scc1 L2B_cx
    s_nop 2
    s_cbranch_vccz L2B_cx
    s_sleep 4
    s_branch L2B_c
L2B_cx:
    s_mov_b32 s43, 0
L2B_q:
    buffer_load_dword v199, v205, s[8:11], s84 offen sc1
    s_add_u32 s43, s43, 1
    s_waitcnt vmcnt(0)
    v_cmp_ne_u32 vcc, 1, v199
    s_cmp_gt_u32 s43, 0x200000
    s_cbranch_scc1 L2B_qx
    s_nop 2
    s_cbranch_vccz L2B_qx
    s_sleep 4
    s_branch L2B_q
L2B_qx:
    s_barrier
    s_barrier
    s_add_u32 m0, s34, 0
    s_nop 0
    buffer_load_dwordx4 v1, s[8:11], s35 offen offset:0 sc1 lds
    buffer_load_dwordx4 v1, s[8:11], s35 offen offset:1024 sc1 lds
    buffer_load_dwordx4 v1, s[8:11], s35 offen offset:2048 sc1 lds
    buffer_load_dwordx4 v1, s[8:11], s35 offen offset:3072 sc1 lds
    s_add_u32 s35, s35, 16384
    s_add_u32 m0, s34, 65536
    s_nop 0
    buffer_load_dwordx4 v1, s[8:11], s36 offen offset:0 sc1 lds
    buffer_load_dwordx4 v1, s[8:11], s36 offen offset:1024 sc1 lds
    buffer_load_dwordx4 v1, s[8:11], s36 offen offset:2048 sc1 lds
    buffer_load_dwordx4 v1, s[8:11], s36 offen offset:3072 sc1 lds
    s_add_u32 s36, s36, 16384
    s_waitcnt vmcnt(0)
    s_barrier
    s_add_u32 m0, s34, 16384
    s_nop 0
    buffer_load_dwordx4 v1, s[8:11], s35 offen offset:0 sc1 lds
    buffer_load_dwordx4 v1, s[8:11], s35 offen offset:1024 sc1 lds
    buffer_load_dwordx4 v1, s[8:11], s35 offen offset:2048 sc1 lds
    buffer_load_dwordx4 v1, s[8:11], s35 offen offset:3072 sc1 lds
    s_add_u32 s35, s35, 16384
    s_add_u32 m0, s34, 81920
    s_nop 0
    buffer_load_dwordx4 v1, s[8:11], s36 offen offset:0 sc1 lds
    buffer_load_dwordx4 v1, s[8:11], s36 offen offset:1024 sc1 lds
    buffer_load_dwordx4 v1, s[8:11], s36 offen offset:2048 sc1 lds
    buffer_load_dwordx4 v1, s[8:11], s36 offen offset:3072 sc1 lds
    s_add_u32 s36, s36, 16384
    s_add_u32 m0, s34, 32768
    s_nop 0
    buffer_load_dwordx4 v1, s[8:11], s35 offen offset:0 sc1 lds
    buffer_load_dwordx4 v1, s[8:11], s35 offen offset:1024 sc1 lds
    buffer_load_dwordx4 v1, s[8:11], s35 offen offset:2048 sc1 lds
    buffer_load_dwordx4 v1, s[8:11], s35 offen offset:3072 sc1 lds
    s_add_u32 s35, s35, 16384
    s_add_u32 m0, s34, 98304
    s_nop 0
    buffer_load_dwordx4 v1, s[8:11], s36 offen offset:0 sc1 lds
    buffer_load_dwordx4 v1, s[8:11], s36 offen offset:1024 sc1 lds
    buffer_load_dwordx4 v1, s[8:11], s36 offen offset:2048 sc1 lds
    buffer_load_dwordx4 v1, s[8:11], s36 offen offset:3072 sc1 lds
    s_add_u32 s36, s36, 16384
    s_sub_u32 s86, s92, 0x20000
    s_sub_u32 s87, s93, 0x20000
    s_sub_u32 s88, s94, 0x20000
    buffer_store_dwordx4 v[208:211], v200, s[8:11], s93 offen offset:0 sc1
    buffer_store_dwordx4 v[212:215], v200, s[8:11], s93 offen offset:256 sc1
    buffer_store_dwordx4 v[216:219], v200, s[8:11], s93 offen offset:2048 sc1
    buffer_store_dwordx4 v[220:223], v200, s[8:11], s93 offen offset:2304 sc1
    buffer_store_dwordx4 v[224:227], v200, s[8:11], s92 offen offset:0 sc1
    buffer_store_dwordx4 v[228:231], v200, s[8:11], s92 offen offset:256 sc1
    buffer_store_dwordx4 v[232:235], v200, s[8:11], s92 offen offset:2048 sc1
    buffer_store_dwordx4 v[236:239], v200, s[8:11], s92 offen offset:2304 sc1
    buffer_store_dwordx4 v[240:243], v200, s[8:11], s94 offen offset:0 sc1
    buffer_store_dwordx4 v[244:247], v200, s[8:11], s94 offen offset:256 sc1
    buffer_store_dwordx4 v[248:251], v200, s[8:11], s94 offen offset:2048 sc1
    buffer_store_dwordx4 v[252:255], v200, s[8:11], s94 offen offset:2304 sc1
    v_mov_b32 v4, 0xdddddddd
    v_bfe_u32 v5, v0, 2, 1
    v_cmp_eq_u32 vcc, 0, v5
    v_mov_b32 v6, 0x3f803f80
    s_nop 0
    v_cndmask_b32 v8, 0, v6, vcc
    v_cndmask_b32 v9, 0, v6, vcc
    v_cndmask_b32 v10, v6, 0, vcc
    v_cndmask_b32 v11, v6, 0, vcc
    s_add_u32 s28, s27, 4194304
    s_add_u32 s29, s28, 8388608
    s_add_u32 s30, s28, 16777216
    s_cmp_eq_u32 s25, 0
    s_cselect_b32 s32, 0, 2048
    s_cselect_b64 s[44:45], 0, -1
    s_sub_u32 s31, s29, s32
    s_sub_u32 s32, s30, s32
    s_add_u32 s37, s37, 4194304
    s_add_u32 s38, s37, 0x10000
    v_lshrrev_b32 v5, 3, v0
    v_lshlrev_b32 v5, 11, v5
    v_and_b32 v6, 7, v0
    v_lshl_add_u32 v2, v6, 7, v5
    v_cmp_gt_u32 vcc, 32, v0
    v_mov_b32 v5, 0x7fffff00
    s_and_b32 s47, s21, 15
    s_lshl_b32 s47, s47, 17
    v_cndmask_b32 v2, v5, v2, vcc
    s_lshl_b32 s46, s34, 3
    s_add_u32 s47, s47, s46
    s_and_b32 s46, s20, 1
    s_lshl_b32 s46, s46, 10
    s_add_u32 s47, s47, s46
    s_lshr_b32 s85, s22, 1
    s_lshl_b32 s85, s85, 5
    s_lshr_b32 s43, s25, 1
    s_add_u32 s85, s85, s43
    s_add_u32 s85, s85, 1407
    s_lshl_b32 s85, s85, 5
    s_add_u32 s85, s85, 33554432
    v_and_b32 v207, 1, v0
    v_and_b32 v206, 1, s44
    v_xor_b32 v206, 1, v206
    v_or_b32 v207, v207, v206
    v_lshlrev_b32 v207, 5, v207
    v_mov_b32 v6, 0xf149f2ca
    v_mov_b32 v92, 0
    v_mov_b32 v93, 0
    v_mov_b32 v94, 0
    v_mov_b32 v95, 0
    v_mov_b32 v96, 0
    v_mov_b32 v97, 0
    v_mov_b32 v98, 0
    v_mov_b32 v99, 0
    v_mov_b32 v100, 0
    v_mov_b32 v101, 0
    v_mov_b32 v102, 0
    v_mov_b32 v103, 0
    v_mov_b32 v104, 0
    v_mov_b32 v105, 0
    v_mov_b32 v106, 0
    v_mov_b32 v107, 0
    v_mov_b32 v108, 0
    v_mov_b32 v109, 0
    v_mov_b32 v110, 0
    v_mov_b32 v111, 0
    s_mov_b32 s48, 0x5555
    s_mov_b32 s49, 0x55550000
    v_cndmask_b32 v12, v6, 0, s[48:49]
    s_mov_b32 s50, 0xaaaa
    s_mov_b32 s51, 0xaaaa0000
    v_cndmask_b32 v13, v6, 0, s[50:51]
    s_mov_b32 s52, 0x15554
    s_mov_b32 s53, 0x55540000
    v_cndmask_b32 v14, v6, 0, s[52:53]
    s_mov_b32 s54, 0x2aaa8
    s_mov_b32 s55, 0xaaa80000
    v_cndmask_b32 v15, v6, 0, s[54:55]
    s_mov_b32 s48, 0x55550
    s_mov_b32 s49, 0x55500000
    v_cndmask_b32 v16, v6, 0, s[48:49]
    s_mov_b32 s50, 0xaaaa0
    s_mov_b32 s51, 0xaaa00000
    v_cndmask_b32 v17, v6, 0, s[50:51]
    s_mov_b32 s52, 0x155540
    s_mov_b32 s53, 0x55400000
    v_cndmask_b32 v18, v6, 0, s[52:53]
    s_mov_b32 s54, 0x2aaa80
    s_mov_b32 s55, 0xaa800000
    v_cndmask_b32 v19, v6, 0, s[54:55]
    s_mov_b32 s48, 0x555500
    s_mov_b32 s49, 0x55000000
    v_cndmask_b32 v20, v6, 0, s[48:49]
    s_mov_b32 s50, 0xaaaa00
    s_mov_b32 s51, 0xaa000000
    v_cndmask_b32 v21, v6, 0, s[50:51]
    s_mov_b32 s52, 0x1555400
    s_mov_b32 s53, 0x54000000
    v_cndmask_b32 v22, v6, 0, s[52:53]
    s_mov_b32 s54, 0x2aaa800
    s_mov_b32 s55, 0xa8000000
    v_cndmask_b32 v23, v6, 0, s[54:55]
    s_mov_b32 s48, 0x5555000
    s_mov_b32 s49, 0x50000000
    v_cndmask_b32 v24, v6, 0, s[48:49]
    s_mov_b32 s50, 0xaaaa000
    s_mov_b32 s51, 0xa0000000
    v_cndmask_b32 v25, v6, 0, s[50:51]
    s_mov_b32 s52, 0x15554000
    s_mov_b32 s53, 0x40000000
    v_cndmask_b32 v26, v6, 0, s[52:53]
    s_mov_b32 s54, 0x2aaa8000
    s_mov_b32 s55, 0x80000000
    v_cndmask_b32 v27, v6, 0, s[54:55]
    s_waitcnt vmcnt(20)
    s_barrier
    s_add_u32 m0, s34, 49152
    s_nop 0
    buffer_load_dwordx4 v1, s[8:11], s35 offen offset:0 sc1 lds
    buffer_load_dwordx4 v1, s[8:11], s35 offen offset:1024 sc1 lds
    buffer_load_dwordx4 v1, s[8:11], s35 offen offset:2048 sc1 lds
    buffer_load_dwordx4 v1, s[8:11], s35 offen offset:3072 sc1 lds
    s_add_u32 s35, s35, 16384
    s_add_u32 m0, s34, 114688
    s_nop 0
    buffer_load_dwordx4 v1, s[8:11], s36 offen offset:0 sc1 lds
    buffer_load_dwordx4 v1, s[8:11], s36 offen offset:1024 sc1 lds
    buffer_load_dwordx4 v1, s[8:11], s36 offen offset:2048 sc1 lds
    buffer_load_dwordx4 v1, s[8:11], s36 offen offset:3072 sc1 lds
    s_add_u32 s36, s36, 16384
    s_waitcnt vmcnt(8)
    s_mov_b64 exec, 1
    buffer_store_dword v204, v203, s[8:11], s95 offen sc1
    s_mov_b64 exec, -1
    v_mov_b32 v6, 0xf149f2ca
    v_mov_b32 v112, 0
    v_mov_b32 v113, 0
    v_mov_b32 v114, 0
    v_mov_b32 v115, 0
    v_mov_b32 v116, 0
    v_mov_b32 v117, 0
    v_mov_b32 v118, 0
    v_mov_b32 v119, 0
    v_mov_b32 v120, 0
    v_mov_b32 v121, 0
    v_mov_b32 v122, 0
    v_mov_b32 v123, 0
    v_mov_b32 v124, 0
    v_mov_b32 v125, 0
    v_mov_b32 v126, 0
    v_mov_b32 v127, 0
    v_mov_b32 v128, 0
    v_mov_b32 v129, 0
    v_mov_b32 v130, 0
    v_mov_b32 v131, 0
    s_mov_b32 s48, 0x0
    s_mov_b32 s49, 0x0
    v_cndmask_b32 v28, v6, 0, s[48:49]
    v_cndmask_b32 v44, v6, v28, s[44:45]
    s_mov_b32 s50, 0x0
    s_mov_b32 s51, 0x0
    v_cndmask_b32 v29, v6, 0, s[50:51]
    v_cndmask_b32 v45, v6, v29, s[44:45]
    s_mov_b32 s52, 0x0
    s_mov_b32 s53, 0x1
    v_cndmask_b32 v30, v6, 0, s[52:53]
    v_cndmask_b32 v46, v6, v30, s[44:45]
    s_mov_b32 s54, 0x0
    s_mov_b32 s55, 0x2
    v_cndmask_b32 v31, v6, 0, s[54:55]
    v_cndmask_b32 v47, v6, v31, s[44:45]
    s_mov_b32 s48, 0x0
    s_mov_b32 s49, 0x5
    v_cndmask_b32 v32, v6, 0, s[48:49]
    v_cndmask_b32 v48, v6, v32, s[44:45]
    s_mov_b32 s50, 0x0
    s_mov_b32 s51, 0xa
    v_cndmask_b32 v33, v6, 0, s[50:51]
    v_cndmask_b32 v49, v6, v33, s[44:45]
    s_mov_b32 s52, 0x0
    s_mov_b32 s53, 0x15
    v_cndmask_b32 v34, v6, 0, s[52:53]
    v_cndmask_b32 v50, v6, v34, s[44:45]
    s_mov_b32 s54, 0x0
    s_mov_b32 s55, 0x2a
    v_cndmask_b32 v35, v6, 0, s[54:55]
    v_cndmask_b32 v51, v6, v35, s[44:45]
    s_mov_b32 s48, 0x0
    s_mov_b32 s49, 0x55
    v_cndmask_b32 v36, v6, 0, s[48:49]
    v_cndmask_b32 v52, v6, v36, s[44:45]
    s_mov_b32 s50, 0x0
    s_mov_b32 s51, 0xaa
    v_cndmask_b32 v37, v6, 0, s[50:51]
    v_cndmask_b32 v53, v6, v37, s[44:45]
    s_mov_b32 s52, 0x0
    s_mov_b32 s53, 0x155
    v_cndmask_b32 v38, v6, 0, s[52:53]
    v_cndmask_b32 v54, v6, v38, s[44:45]
    s_mov_b32 s54, 0x0
    s_mov_b32 s55, 0x2aa
    v_cndmask_b32 v39, v6, 0, s[54:55]
    v_cndmask_b32 v55, v6, v39, s[44:45]
    s_mov_b32 s48, 0x0
    s_mov_b32 s49, 0x555
    v_cndmask_b32 v40, v6, 0, s[48:49]
    v_cndmask_b32 v56, v6, v40, s[44:45]
    s_mov_b32 s50, 0x0
    s_mov_b32 s51, 0xaaa
    v_cndmask_b32 v41, v6, 0, s[50:51]
    v_cndmask_b32 v57, v6, v41, s[44:45]
    s_mov_b32 s52, 0x0
    s_mov_b32 s53, 0x1555
    v_cndmask_b32 v42, v6, 0, s[52:53]
    v_cndmask_b32 v58, v6, v42, s[44:45]
    s_mov_b32 s54, 0x0
    s_mov_b32 s55, 0x2aaa
    v_cndmask_b32 v43, v6, 0, s[54:55]
    v_cndmask_b32 v59, v6, v43, s[44:45]
    v_lshrrev_b32 v5, 4, v0
    v_and_b32 v199, 15, v0
    v_lshlrev_b32 v196, 1, v5
    v_xor_b32 v199, v199, v196
    v_lshlrev_b32 v199, 4, v199
    v_lshl_add_u32 v196, v5, 11, v199
    v_xor_b32 v197, 128, v196
    v_add_u32 v197, 8192, v197
    v_and_b32 v198, 31, v0
    v_lshlrev_b32 v198, 5, v198
    s_lshl_b32 s39, s60, 22
    s_lshl_b32 s40, s61, 18
    s_add_u32 s39, s39, s40
    s_lshl_b32 s40, s34, 4
    s_add_u32 s39, s39, s40
    s_add_u32 s39, s39, 25165824
    s_lshl_b32 s40, s34, 3
    s_lshl_b32 s41, s62, 8
    s_add_u32 s40, s40, s41
    s_add_u32 s41, s40, 16384
    s_lshl_b32 s42, s61, 1
    s_lshr_b32 s43, s34, 13
    s_add_u32 s42, s42, s43
    s_add_u32 s42, s42, 8
    s_lshr_b32 s43, s61, 1
    s_cmp_eq_u32 s60, 0
    s_cselect_b32 s42, s43, s42
    s_lshl_b32 s42, s42, 10
    s_add_u32 s42, s42, 33554432
    s_lshl_b32 s89, s25, 4
    s_add_u32 s89, s89, s22
    s_add_u32 s89, s89, 256
    s_lshl_b32 s89, s89, 5
    s_add_u32 s89, s89, 33554432
    s_waitcnt vmcnt(21)
    s_barrier
    s_add_u32 m0, s34, 0
    s_nop 0
    buffer_load_dwordx4 v1, s[8:11], s35 offen offset:0 sc1 lds
    buffer_load_dwordx4 v1, s[8:11], s35 offen offset:1024 sc1 lds
    buffer_load_dwordx4 v1, s[8:11], s35 offen offset:2048 sc1 lds
    buffer_load_dwordx4 v1, s[8:11], s35 offen offset:3072 sc1 lds
    s_add_u32 s35, s35, 16384
    s_add_u32 m0, s34, 65536
    s_nop 0
    buffer_load_dwordx4 v1, s[8:11], s36 offen offset:0 sc1 lds
    buffer_load_dwordx4 v1, s[8:11], s36 offen offset:1024 sc1 lds
    buffer_load_dwordx4 v1, s[8:11], s36 offen offset:2048 sc1 lds
    buffer_load_dwordx4 v1, s[8:11], s36 offen offset:3072 sc1 lds
    s_add_u32 s36, s36, 16384
    s_mov_b32 s43, 0
L2B_b:
    buffer_load_dword v199, v207, s[8:11], s85 offen sc1
    s_add_u32 s43, s43, 1
    s_waitcnt vmcnt(0)
    v_cmp_ne_u32 vcc, 1, v199
    s_cmp_gt_u32 s43, 0x200000
    s_cbranch_scc1 L2B_bx
    s_nop 2
    s_cbranch_vccz L2B_bx
    s_sleep 4
    s_branch L2B_b
L2B_bx:
    buffer_load_dwordx4 v[132:135], v1, s[8:11], s28 offen offset:0 sc1
    buffer_load_dwordx4 v[136:139], v1, s[8:11], s28 offen offset:1024 sc1
    buffer_load_dwordx4 v[140:143], v1, s[8:11], s28 offen offset:2048 sc1
    buffer_load_dwordx4 v[144:147], v1, s[8:11], s28 offen offset:3072 sc1
    buffer_load_dwordx4 v[148:151], v7, s[8:11], s31 offen offset:0 sc1
    buffer_load_dwordx4 v[152:155], v7, s[8:11], s31 offen offset:1024 sc1
    buffer_load_dwordx4 v[156:159], v7, s[8:11], s29 offen offset:0 sc1
    buffer_load_dwordx4 v[160:163], v7, s[8:11], s29 offen offset:1024 sc1
    buffer_load_dwordx4 v[164:167], v7, s[8:11], s29 offen offset:2048 sc1
    buffer_load_dwordx4 v[168:171], v7, s[8:11], s29 offen offset:3072 sc1
    buffer_load_dwordx4 v[172:175], v1, s[8:11], s32 offen offset:0 sc1
    buffer_load_dwordx4 v[176:179], v1, s[8:11], s32 offen offset:1024 sc1
    buffer_load_dwordx4 v[180:183], v1, s[8:11], s30 offen offset:0 sc1
    buffer_load_dwordx4 v[184:187], v1, s[8:11], s30 offen offset:1024 sc1
    buffer_load_dwordx4 v[188:191], v1, s[8:11], s30 offen offset:2048 sc1
    buffer_load_dwordx4 v[192:195], v1, s[8:11], s30 offen offset:3072 sc1
    buffer_load_dword v3, v2, s[16:19], s47 offen
    s_add_u32 s47, s47, 8192
    s_barrier
    s_add_u32 m0, s34, 16384
    s_nop 0
    buffer_load_dwordx4 v1, s[8:11], s35 offen offset:0 sc1 lds
    buffer_load_dwordx4 v1, s[8:11], s35 offen offset:1024 sc1 lds
    buffer_load_dwordx4 v1, s[8:11], s35 offen offset:2048 sc1 lds
    buffer_load_dwordx4 v1, s[8:11], s35 offen offset:3072 sc1 lds
    s_add_u32 s35, s35, 16384
    s_add_u32 m0, s34, 81920
    s_nop 0
    buffer_load_dwordx4 v1, s[8:11], s36 offen offset:0 sc1 lds
    buffer_load_dwordx4 v1, s[8:11], s36 offen offset:1024 sc1 lds
    buffer_load_dwordx4 v1, s[8:11], s36 offen offset:2048 sc1 lds
    buffer_load_dwordx4 v1, s[8:11], s36 offen offset:3072 sc1 lds
    s_add_u32 s36, s36, 16384
    s_waitcnt vmcnt(9)
    buffer_load_dword v3, v2, s[16:19], s47 offen
    s_add_u32 s47, s47, 8192
    v_mfma_f32_32x32x16_bf16 v[60:75], v[156:159], v[132:135], v[12:27]
    v_mfma_f32_32x32x16_bf16 v[76:91], v[148:151], v[132:135], v[44:59]
    v_mfma_f32_32x32x16_bf16 v[60:75], v[160:163], v[136:139], v[60:75]
    v_mfma_f32_32x32x16_bf16 v[76:91], v[152:155], v[136:139], v[76:91]
    s_nop 10
    v_max3_f32 v5, v60, v61, v62
    v_max3_f32 v6, v63, v64, v65
    v_max3_f32 v5, v5, v66, v67
    v_max3_f32 v6, v6, v68, v69
    v_max3_f32 v5, v5, v70, v71
    v_max3_f32 v6, v6, v72, v73
    v_max3_f32 v5, v5, v74, v75
    v_max3_f32 v6, v6, v76, v77
    v_max3_f32 v5, v5, v78, v79
    v_max3_f32 v6, v6, v80, v81
    v_max3_f32 v5, v5, v82, v83
    v_max3_f32 v6, v6, v84, v85
    v_max3_f32 v5, v5, v86, v87
    v_max3_f32 v6, v6, v88, v89
    v_max3_f32 v5, v5, v90, v91
    v_max_f32 v5, v5, v6
    s_nop 0
    v_mov_b32 v6, v5
    s_nop 1
    v_permlane32_swap_b32 v5, v6
    s_nop 1
    v_max_f32 v5, v5, v6
    v_sub_f32 v60, v60, v5
    v_sub_f32 v61, v61, v5
    v_sub_f32 v62, v62, v5
    v_sub_f32 v63, v63, v5
    v_sub_f32 v64, v64, v5
    v_sub_f32 v65, v65, v5
    v_sub_f32 v66, v66, v5
    v_sub_f32 v67, v67, v5
    v_sub_f32 v68, v68, v5
    v_sub_f32 v69, v69, v5
    v_sub_f32 v70, v70, v5
    v_sub_f32 v71, v71, v5
    v_sub_f32 v72, v72, v5
    v_sub_f32 v73, v73, v5
    v_sub_f32 v74, v74, v5
    v_sub_f32 v75, v75, v5
    v_sub_f32 v76, v76, v5
    v_sub_f32 v77, v77, v5
    v_sub_f32 v78, v78, v5
    v_sub_f32 v79, v79, v5
    v_sub_f32 v80, v80, v5
    v_sub_f32 v81, v81, v5
    v_sub_f32 v82, v82, v5
    v_sub_f32 v83, v83, v5
    v_sub_f32 v84, v84, v5
    v_sub_f32 v85, v85, v5
    v_sub_f32 v86, v86, v5
    v_sub_f32 v87, v87, v5
    v_sub_f32 v88, v88, v5
    v_sub_f32 v89, v89, v5
    v_sub_f32 v90, v90, v5
    v_sub_f32 v91, v91, v5
    v_exp_f32 v60, v60
    v_exp_f32 v61, v61
    v_exp_f32 v62, v62
    v_exp_f32 v63, v63
    v_exp_f32 v64, v64
    v_exp_f32 v65, v65
    v_exp_f32 v66, v66
    v_exp_f32 v67, v67
    v_exp_f32 v68, v68
    v_exp_f32 v69, v69
    v_exp_f32 v70, v70
    v_exp_f32 v71, v71
    v_exp_f32 v72, v72
    v_exp_f32 v73, v73
    v_exp_f32 v74, v74
    v_exp_f32 v75, v75
    v_exp_f32 v76, v76
    v_exp_f32 v77, v77
    v_exp_f32 v78, v78
    v_exp_f32 v79, v79
    v_exp_f32 v80, v80
    v_exp_f32 v81, v81
    v_exp_f32 v82, v82
    v_exp_f32 v83, v83
    v_exp_f32 v84, v84
    v_exp_f32 v85, v85
    v_exp_f32 v86, v86
    v_exp_f32 v87, v87
    v_exp_f32 v88, v88
    s_barrier
    s_add_u32 m0, s34, 32768
    s_nop 0
    buffer_load_dwordx4 v1, s[8:11], s35 offen offset:0 sc1 lds
    buffer_load_dwordx4 v1, s[8:11], s35 offen offset:1024 sc1 lds
    buffer_load_dwordx4 v1, s[8:11], s35 offen offset:2048 sc1 lds
    buffer_load_dwordx4 v1, s[8:11], s35 offen offset:3072 sc1 lds
    s_add_u32 s35, s35, 16384
    s_add_u32 m0, s34, 98304
    s_nop 0
    buffer_load_dwordx4 v1, s[8:11], s36 offen offset:0 sc1 lds
    buffer_load_dwordx4 v1, s[8:11], s36 offen offset:1024 sc1 lds
    buffer_load_dwordx4 v1, s[8:11], s36 offen offset:2048 sc1 lds
    buffer_load_dwordx4 v1, s[8:11], s36 offen offset:3072 sc1 lds
    s_add_u32 s36, s36, 16384
    buffer_load_dword v3, v2, s[16:19], s47 offen
    s_add_u32 s47, s47, 8192
    v_exp_f32 v89, v89
    v_exp_f32 v90, v90
    v_exp_f32 v91, v91
    s_nop 1
    v_smfmac_f32_32x32x32_bf16 v[92:107], v[180:183], v[60:67], v4
    v_smfmac_f32_16x16x64_bf16 v[108:111], v[8:11], v[60:67], v4
    v_smfmac_f32_32x32x32_bf16 v[92:107], v[184:187], v[68:75], v4
    v_smfmac_f32_16x16x64_bf16 v[108:111], v[8:11], v[68:75], v4
    v_smfmac_f32_32x32x32_bf16 v[92:107], v[172:175], v[76:83], v4
    v_smfmac_f32_16x16x64_bf16 v[108:111], v[8:11], v[76:83], v4
    v_smfmac_f32_16x16x64_bf16 v[108:111], v[8:11], v[84:91], v4
    v_smfmac_f32_32x32x32_bf16 v[92:107], v[176:179], v[84:91], v4
    s_nop 12
    v_rcp_f32 v6, v108
    s_nop 0
    v_mul_f32 v92, v92, v6
    v_mul_f32 v93, v93, v6
    v_mul_f32 v94, v94, v6
    v_mul_f32 v95, v95, v6
    v_mul_f32 v96, v96, v6
    v_mul_f32 v97, v97, v6
    v_mul_f32 v98, v98, v6
    v_mul_f32 v99, v99, v6
    v_mul_f32 v100, v100, v6
    v_mul_f32 v101, v101, v6
    v_mul_f32 v102, v102, v6
    v_mul_f32 v103, v103, v6
    v_mul_f32 v104, v104, v6
    v_mul_f32 v105, v105, v6
    v_mul_f32 v106, v106, v6
    v_mul_f32 v107, v107, v6
    v_cvt_pk_bf16_f32 v132, v92, v93
    v_cvt_pk_bf16_f32 v133, v94, v95
    v_cvt_pk_bf16_f32 v134, v96, v97
    v_cvt_pk_bf16_f32 v135, v98, v99
    v_cvt_pk_bf16_f32 v136, v100, v101
    v_cvt_pk_bf16_f32 v137, v102, v103
    v_cvt_pk_bf16_f32 v138, v104, v105
    v_cvt_pk_bf16_f32 v139, v106, v107
    buffer_store_dwordx4 v[132:135], v1, s[8:11], s37 offen sc1
    buffer_store_dwordx4 v[136:139], v1, s[8:11], s37 offen offset:1024 sc1
    v_mfma_f32_32x32x16_bf16 v[60:75], v[164:167], v[140:143], v[12:27]
    v_mfma_f32_32x32x16_bf16 v[76:91], v[156:159], v[140:143], v[28:43]
    v_mfma_f32_32x32x16_bf16 v[60:75], v[168:171], v[144:147], v[60:75]
    v_mfma_f32_32x32x16_bf16 v[76:91], v[160:163], v[144:147], v[76:91]
    s_nop 10
    v_max3_f32 v5, v60, v61, v62
    v_max3_f32 v6, v63, v64, v65
    v_max3_f32 v5, v5, v66, v67
    v_max3_f32 v6, v6, v68, v69
    v_max3_f32 v5, v5, v70, v71
    v_max3_f32 v6, v6, v72, v73
    v_max3_f32 v5, v5, v74, v75
    v_max3_f32 v6, v6, v76, v77
    v_max3_f32 v5, v5, v78, v79
    v_max3_f32 v6, v6, v80, v81
    v_max3_f32 v5, v5, v82, v83
    v_max3_f32 v6, v6, v84, v85
    v_max3_f32 v5, v5, v86, v87
    v_max3_f32 v6, v6, v88, v89
    v_max3_f32 v5, v5, v90, v91
    v_max_f32 v5, v5, v6
    s_nop 0
    v_mov_b32 v6, v5
    s_nop 1
    v_permlane32_swap_b32 v5, v6
    s_nop 1
    v_max_f32 v5, v5, v6
    v_sub_f32 v60, v60, v5
    v_sub_f32 v61, v61, v5
    v_sub_f32 v62, v62, v5
    v_sub_f32 v63, v63, v5
    v_sub_f32 v64, v64, v5
    v_sub_f32 v65, v65, v5
    v_sub_f32 v66, v66, v5
    v_sub_f32 v67, v67, v5
    v_sub_f32 v68, v68, v5
    v_sub_f32 v69, v69, v5
    v_sub_f32 v70, v70, v5
    v_sub_f32 v71, v71, v5
    v_sub_f32 v72, v72, v5
    v_sub_f32 v73, v73, v5
    v_sub_f32 v74, v74, v5
    v_sub_f32 v75, v75, v5
    v_sub_f32 v76, v76, v5
    v_sub_f32 v77, v77, v5
    v_sub_f32 v78, v78, v5
    v_sub_f32 v79, v79, v5
    v_sub_f32 v80, v80, v5
    v_sub_f32 v81, v81, v5
    v_sub_f32 v82, v82, v5
    v_sub_f32 v83, v83, v5
    v_sub_f32 v84, v84, v5
    v_sub_f32 v85, v85, v5
    v_sub_f32 v86, v86, v5
    s_waitcnt vmcnt(12)
    s_barrier
    s_add_u32 m0, s34, 49152
    s_nop 0
    buffer_load_dwordx4 v1, s[8:11], s35 offen offset:0 sc1 lds
    buffer_load_dwordx4 v1, s[8:11], s35 offen offset:1024 sc1 lds
    buffer_load_dwordx4 v1, s[8:11], s35 offen offset:2048 sc1 lds
    buffer_load_dwordx4 v1, s[8:11], s35 offen offset:3072 sc1 lds
    s_add_u32 s35, s35, 16384
    s_add_u32 m0, s34, 114688
    s_nop 0
    buffer_load_dwordx4 v1, s[8:11], s36 offen offset:0 sc1 lds
    buffer_load_dwordx4 v1, s[8:11], s36 offen offset:1024 sc1 lds
    buffer_load_dwordx4 v1, s[8:11], s36 offen offset:2048 sc1 lds
    buffer_load_dwordx4 v1, s[8:11], s36 offen offset:3072 sc1 lds
    s_add_u32 s36, s36, 16384
    buffer_load_dword v3, v2, s[16:19], s47 offen
    s_add_u32 s47, s47, 8192
    s_mov_b32 s12, s58
    s_mov_b32 s13, s59
    s_mov_b32 s14, 0x800000
    s_mov_b32 s15, 0x00020000
    v_lshlrev_b32 v206, 21, v0
    buffer_load_dword v206, v206, s[12:15], 0 offen
    v_sub_f32 v87, v87, v5
    v_sub_f32 v88, v88, v5
    v_sub_f32 v89, v89, v5
    v_sub_f32 v90, v90, v5
    v_sub_f32 v91, v91, v5
    v_exp_f32 v60, v60
    v_exp_f32 v61, v61
    v_exp_f32 v62, v62
    v_exp_f32 v63, v63
    v_exp_f32 v64, v64
    v_exp_f32 v65, v65
    v_exp_f32 v66, v66
    v_exp_f32 v67, v67
    v_exp_f32 v68, v68
    v_exp_f32 v69, v69
    v_exp_f32 v70, v70
    v_exp_f32 v71, v71
    v_exp_f32 v72, v72
    v_exp_f32 v73, v73
    v_exp_f32 v74, v74
    v_exp_f32 v75, v75
    v_exp_f32 v76, v76
    v_exp_f32 v77, v77
    v_exp_f32 v78, v78
    v_exp_f32 v79, v79
    v_exp_f32 v80, v80
    v_exp_f32 v81, v81
    v_exp_f32 v82, v82
    v_exp_f32 v83, v83
    v_exp_f32 v84, v84
    v_exp_f32 v85, v85
    v_exp_f32 v86, v86
    v_exp_f32 v87, v87
    v_exp_f32 v88, v88
    v_exp_f32 v89, v89
    v_exp_f32 v90, v90
    v_exp_f32 v91, v91
    s_nop 1
    v_smfmac_f32_32x32x32_bf16 v[112:127], v[188:191], v[60:67], v4
    v_smfmac_f32_16x16x64_bf16 v[128:131], v[8:11], v[60:67], v4
    v_smfmac_f32_32x32x32_bf16 v[112:127], v[192:195], v[68:75], v4
    v_smfmac_f32_16x16x64_bf16 v[128:131], v[8:11], v[68:75], v4
    v_smfmac_f32_32x32x32_bf16 v[112:127], v[180:183], v[76:83], v4
    v_smfmac_f32_16x16x64_bf16 v[128:131], v[8:11], v[76:83], v4
    v_smfmac_f32_16x16x64_bf16 v[128:131], v[8:11], v[84:91], v4
    v_smfmac_f32_32x32x32_bf16 v[112:127], v[184:187], v[84:91], v4
    s_nop 12
    v_rcp_f32 v6, v128
    s_nop 0
    v_mul_f32 v112, v112, v6
    v_mul_f32 v113, v113, v6
    v_mul_f32 v114, v114, v6
    v_mul_f32 v115, v115, v6
    v_mul_f32 v116, v116, v6
    v_mul_f32 v117, v117, v6
    v_mul_f32 v118, v118, v6
    v_mul_f32 v119, v119, v6
    v_mul_f32 v120, v120, v6
    v_mul_f32 v121, v121, v6
    v_mul_f32 v122, v122, v6
    v_mul_f32 v123, v123, v6
    v_mul_f32 v124, v124, v6
    v_mul_f32 v125, v125, v6
    v_mul_f32 v126, v126, v6
    v_mul_f32 v127, v127, v6
    v_cvt_pk_bf16_f32 v140, v112, v113
    v_cvt_pk_bf16_f32 v141, v114, v115
    v_cvt_pk_bf16_f32 v142, v116, v117
    v_cvt_pk_bf16_f32 v143, v118, v119
    v_cvt_pk_bf16_f32 v144, v120, v121
    v_cvt_pk_bf16_f32 v145, v122, v123
    v_cvt_pk_bf16_f32 v146, v124, v125
    v_cvt_pk_bf16_f32 v147, v126, v127
    buffer_store_dwordx4 v[140:143], v1, s[8:11], s38 offen sc1
    buffer_store_dwordx4 v[144:147], v1, s[8:11], s38 offen offset:1024 sc1
    s_waitcnt vmcnt(15)
    s_barrier
    s_waitcnt vmcnt(0)
    s_mov_b64 exec, 1
    buffer_store_dword v204, v203, s[8:11], s89 offen sc1
    s_mov_b64 exec, -1
    s_add_u32 m0, s34, 147456
    s_nop 0
    buffer_load_dwordx4 v196, s[16:19], s40 offen lds
    s_add_u32 m0, m0, 1024
    s_nop 0
    buffer_load_dwordx4 v197, s[16:19], s40 offen lds
    s_add_u32 m0, m0, 1024
    s_add_u32 s40, s40, 131072
    buffer_load_dwordx4 v196, s[16:19], s41 offen lds
    s_add_u32 m0, m0, 1024
    s_nop 0
    buffer_load_dwordx4 v197, s[16:19], s41 offen lds
    s_add_u32 s41, s41, 131072
    s_add_u32 m0, s34, 16384
    s_nop 0
    buffer_load_dwordx4 v196, s[16:19], s40 offen lds
    s_add_u32 m0, m0, 1024
    s_nop 0
    buffer_load_dwordx4 v197, s[16:19], s40 offen lds
    s_add_u32 m0, m0, 1024
    s_add_u32 s40, s40, 131072
    buffer_load_dwordx4 v196, s[16:19], s41 offen lds
    s_add_u32 m0, m0, 1024
    s_nop 0
    buffer_load_dwordx4 v197, s[16:19], s41 offen lds
    s_add_u32 s41, s41, 131072
    s_waitcnt vmcnt(13)
    s_barrier
    s_add_u32 m0, s34, 81920
    s_nop 0
    buffer_load_dwordx4 v196, s[16:19], s40 offen lds
    s_add_u32 m0, m0, 1024
    s_nop 0
    buffer_load_dwordx4 v197, s[16:19], s40 offen lds
    s_add_u32 m0, m0, 1024
    s_add_u32 s40, s40, 131072
    buffer_load_dwordx4 v196, s[16:19], s41 offen lds
    s_add_u32 m0, m0, 1024
    s_nop 0
    buffer_load_dwordx4 v197, s[16:19], s41 offen lds
    s_add_u32 s41, s41, 131072
    s_mov_b32 s43, 0
L2B_o:
    buffer_load_dword v199, v198, s[8:11], s42 offen sc1
    s_add_u32 s43, s43, 1
    s_waitcnt vmcnt(0)
    v_cmp_ne_u32 vcc, 1, v199
    s_cmp_gt_u32 s43, 0x200000
    s_cbranch_scc1 L2B_ox
    s_nop 2
    s_cbranch_vccz L2B_ox
    s_sleep 4
    s_branch L2B_o
L2B_ox:
    s_add_u32 m0, s34, 131072
    s_nop 0
    buffer_load_dwordx4 v1, s[8:11], s39 offen offset:0 sc1 lds
    buffer_load_dwordx4 v1, s[8:11], s39 offen offset:1024 sc1 lds
    buffer_load_dwordx4 v1, s[8:11], s39 offen offset:2048 sc1 lds
    buffer_load_dwordx4 v1, s[8:11], s39 offen offset:3072 sc1 lds
    s_add_u32 s39, s39, 4096
    s_add_u32 m0, s34, 0
    s_nop 0
    buffer_load_dwordx4 v1, s[8:11], s39 offen offset:0 sc1 lds
    buffer_load_dwordx4 v1, s[8:11], s39 offen offset:1024 sc1 lds
    buffer_load_dwordx4 v1, s[8:11], s39 offen offset:2048 sc1 lds
    buffer_load_dwordx4 v1, s[8:11], s39 offen offset:3072 sc1 lds
    s_add_u32 s39, s39, 4096
    s_add_u32 m0, s34, 65536
    s_nop 0
    buffer_load_dwordx4 v1, s[8:11], s39 offen offset:0 sc1 lds
    buffer_load_dwordx4 v1, s[8:11], s39 offen offset:1024 sc1 lds
    buffer_load_dwordx4 v1, s[8:11], s39 offen offset:2048 sc1 lds
    buffer_load_dwordx4 v1, s[8:11], s39 offen offset:3072 sc1 lds
    s_add_u32 s39, s39, 4096
    s_barrier
    s_cmp_lg_u32 s24, 4
    s_cbranch_scc1 L2B_p3
    s_mov_b64 exec, 1
    buffer_store_dword v204, v203, s[8:11], s63 offen sc1
    s_mov_b64 exec, -1
L2B_p3:
    s_barrier
    s_waitcnt vmcnt(8)
    s_barrier
    s_add_u32 m0, s34, 49152
    s_nop 0
    buffer_load_dwordx4 v196, s[16:19], s40 offen lds
    s_add_u32 m0, m0, 1024
    s_nop 0
    buffer_load_dwordx4 v197, s[16:19], s40 offen lds
    s_add_u32 m0, m0, 1024
    s_add_u32 s40, s40, 131072
    buffer_load_dwordx4 v196, s[16:19], s41 offen lds
    s_add_u32 m0, m0, 1024
    s_nop 0
    buffer_load_dwordx4 v197, s[16:19], s41 offen lds
    s_add_u32 s41, s41, 131072
    s_add_u32 m0, s34, 32768
    s_nop 0
    buffer_load_dwordx4 v1, s[8:11], s39 offen offset:0 sc1 lds
    buffer_load_dwordx4 v1, s[8:11], s39 offen offset:1024 sc1 lds
    buffer_load_dwordx4 v1, s[8:11], s39 offen offset:2048 sc1 lds
    buffer_load_dwordx4 v1, s[8:11], s39 offen offset:3072 sc1 lds
    s_add_u32 s39, s39, 4096
    s_add_u32 m0, s34, 114688
    s_nop 0
    buffer_load_dwordx4 v196, s[16:19], s40 offen lds
    s_add_u32 m0, m0, 1024
    s_nop 0
    buffer_load_dwordx4 v197, s[16:19], s40 offen lds
    s_add_u32 m0, m0, 1024
    s_add_u32 s40, s40, 131072
    buffer_load_dwordx4 v196, s[16:19], s41 offen lds
    s_add_u32 m0, m0, 1024
    s_nop 0
    buffer_load_dwordx4 v197, s[16:19], s41 offen lds
    s_add_u32 s41, s41, 131072
    s_add_u32 m0, s34, 98304
    s_nop 0
    buffer_load_dwordx4 v1, s[8:11], s39 offen offset:0 sc1 lds
    buffer_load_dwordx4 v1, s[8:11], s39 offen offset:1024 sc1 lds
    buffer_load_dwordx4 v1, s[8:11], s39 offen offset:2048 sc1 lds
    buffer_load_dwordx4 v1, s[8:11], s39 offen offset:3072 sc1 lds
    s_add_u32 s39, s39, 4096
    s_waitcnt vmcnt(20)
    s_barrier
    s_add_u32 m0, s34, 147456
    s_nop 0
    buffer_load_dwordx4 v196, s[16:19], s40 offen lds
    s_add_u32 m0, m0, 1024
    s_nop 0
    buffer_load_dwordx4 v197, s[16:19], s40 offen lds
    s_add_u32 m0, m0, 1024
    s_add_u32 s40, s40, 131072
    buffer_load_dwordx4 v196, s[16:19], s41 offen lds
    s_add_u32 m0, m0, 1024
    s_nop 0
    buffer_load_dwordx4 v197, s[16:19], s41 offen lds
    s_add_u32 s41, s41, 131072
    s_add_u32 m0, s34, 131072
    s_nop 0
    buffer_load_dwordx4 v1, s[8:11], s39 offen offset:0 sc1 lds
    buffer_load_dwordx4 v1, s[8:11], s39 offen offset:1024 sc1 lds
    buffer_load_dwordx4 v1, s[8:11], s39 offen offset:2048 sc1 lds
    buffer_load_dwordx4 v1, s[8:11], s39 offen offset:3072 sc1 lds
    s_add_u32 s39, s39, 4096
    s_waitcnt vmcnt(24)
    s_barrier
    s_add_u32 m0, s34, 16384
    s_nop 0
    buffer_load_dwordx4 v196, s[16:19], s40 offen lds
    s_add_u32 m0, m0, 1024
    s_nop 0
    buffer_load_dwordx4 v197, s[16:19], s40 offen lds
    s_add_u32 m0, m0, 1024
    s_add_u32 s40, s40, 131072
    buffer_load_dwordx4 v196, s[16:19], s41 offen lds
    s_add_u32 m0, m0, 1024
    s_nop 0
    buffer_load_dwordx4 v197, s[16:19], s41 offen lds
    s_add_u32 s41, s41, 131072
    s_add_u32 m0, s34, 0
    s_nop 0
    buffer_load_dwordx4 v1, s[8:11], s39 offen offset:0 sc1 lds
    buffer_load_dwordx4 v1, s[8:11], s39 offen offset:1024 sc1 lds
    buffer_load_dwordx4 v1, s[8:11], s39 offen offset:2048 sc1 lds
    buffer_load_dwordx4 v1, s[8:11], s39 offen offset:3072 sc1 lds
    s_add_u32 s39, s39, 4096
    s_waitcnt vmcnt(24)
    s_barrier
    s_add_u32 m0, s34, 81920
    s_nop 0
    buffer_load_dwordx4 v196, s[16:19], s40 offen lds
    s_add_u32 m0, m0, 1024
    s_nop 0
    buffer_load_dwordx4 v197, s[16:19], s40 offen lds
    s_add_u32 m0, m0, 1024
    s_add_u32 s40, s40, 131072
    buffer_load_dwordx4 v196, s[16:19], s41 offen lds
    s_add_u32 m0, m0, 1024
    s_nop 0
    buffer_load_dwordx4 v197, s[16:19], s41 offen lds
    s_add_u32 s41, s41, 131072
    s_add_u32 m0, s34, 65536
    s_nop 0
    buffer_load_dwordx4 v1, s[8:11], s39 offen offset:0 sc1 lds
    buffer_load_dwordx4 v1, s[8:11], s39 offen offset:1024 sc1 lds
    buffer_load_dwordx4 v1, s[8:11], s39 offen offset:2048 sc1 lds
    buffer_load_dwordx4 v1, s[8:11], s39 offen offset:3072 sc1 lds
    s_add_u32 s39, s39, 4096
    s_waitcnt vmcnt(24)
    s_barrier
    s_add_u32 m0, s34, 49152
    s_nop 0
    buffer_load_dwordx4 v196, s[16:19], s40 offen lds
    s_add_u32 m0, m0, 1024
    s_nop 0
    buffer_load_dwordx4 v197, s[16:19], s40 offen lds
    s_add_u32 m0, m0, 1024
    s_add_u32 s40, s40, 131072
    buffer_load_dwordx4 v196, s[16:19], s41 offen lds
    s_add_u32 m0, m0, 1024
    s_nop 0
    buffer_load_dwordx4 v197, s[16:19], s41 offen lds
    s_add_u32 s41, s41, 131072
    s_add_u32 m0, s34, 32768
    s_nop 0
    buffer_load_dwordx4 v1, s[8:11], s39 offen offset:0 sc1 lds
    buffer_load_dwordx4 v1, s[8:11], s39 offen offset:1024 sc1 lds
    buffer_load_dwordx4 v1, s[8:11], s39 offen offset:2048 sc1 lds
    buffer_load_dwordx4 v1, s[8:11], s39 offen offset:3072 sc1 lds
    s_add_u32 s39, s39, 4096
    s_waitcnt vmcnt(24)
    s_barrier
    s_add_u32 m0, s34, 114688
    s_nop 0
    buffer_load_dwordx4 v196, s[16:19], s40 offen lds
    s_add_u32 m0, m0, 1024
    s_nop 0
    buffer_load_dwordx4 v197, s[16:19], s40 offen lds
    s_add_u32 m0, m0, 1024
    s_add_u32 s40, s40, 131072
    buffer_load_dwordx4 v196, s[16:19], s41 offen lds
    s_add_u32 m0, m0, 1024
    s_nop 0
    buffer_load_dwordx4 v197, s[16:19], s41 offen lds
    s_add_u32 s41, s41, 131072
    s_add_u32 m0, s34, 98304
    s_nop 0
    buffer_load_dwordx4 v1, s[8:11], s39 offen offset:0 sc1 lds
    buffer_load_dwordx4 v1, s[8:11], s39 offen offset:1024 sc1 lds
    buffer_load_dwordx4 v1, s[8:11], s39 offen offset:2048 sc1 lds
    buffer_load_dwordx4 v1, s[8:11], s39 offen offset:3072 sc1 lds
    s_add_u32 s39, s39, 4096
    s_waitcnt vmcnt(24)
    s_barrier
    s_add_u32 m0, s34, 147456
    s_nop 0
    buffer_load_dwordx4 v196, s[16:19], s40 offen lds
    s_add_u32 m0, m0, 1024
    s_nop 0
    buffer_load_dwordx4 v197, s[16:19], s40 offen lds
    s_add_u32 m0, m0, 1024
    s_add_u32 s40, s40, 131072
    buffer_load_dwordx4 v196, s[16:19], s41 offen lds
    s_add_u32 m0, m0, 1024
    s_nop 0
    buffer_load_dwordx4 v197, s[16:19], s41 offen lds
    s_add_u32 s41, s41, 131072
    s_add_u32 m0, s34, 131072
    s_nop 0
    buffer_load_dwordx4 v1, s[8:11], s39 offen offset:0 sc1 lds
    buffer_load_dwordx4 v1, s[8:11], s39 offen offset:1024 sc1 lds
    buffer_load_dwordx4 v1, s[8:11], s39 offen offset:2048 sc1 lds
    buffer_load_dwordx4 v1, s[8:11], s39 offen offset:3072 sc1 lds
    s_add_u32 s39, s39, 4096
    s_waitcnt vmcnt(24)
    s_barrier
    s_add_u32 m0, s34, 16384
    s_nop 0
    buffer_load_dwordx4 v196, s[16:19], s40 offen lds
    s_add_u32 m0, m0, 1024
    s_nop 0
    buffer_load_dwordx4 v197, s[16:19], s40 offen lds
    s_add_u32 m0, m0, 1024
    s_add_u32 s40, s40, 131072
    buffer_load_dwordx4 v196, s[16:19], s41 offen lds
    s_add_u32 m0, m0, 1024
    s_nop 0
    buffer_load_dwordx4 v197, s[16:19], s41 offen lds
    s_add_u32 s41, s41, 131072
    s_add_u32 m0, s34, 0
    s_nop 0
    buffer_load_dwordx4 v1, s[8:11], s39 offen offset:0 sc1 lds
    buffer_load_dwordx4 v1, s[8:11], s39 offen offset:1024 sc1 lds
    buffer_load_dwordx4 v1, s[8:11], s39 offen offset:2048 sc1 lds
    buffer_load_dwordx4 v1, s[8:11], s39 offen offset:3072 sc1 lds
    s_add_u32 s39, s39, 4096
    s_waitcnt vmcnt(24)
    s_barrier
    s_add_u32 m0, s34, 81920
    s_nop 0
    buffer_load_dwordx4 v196, s[16:19], s40 offen lds
    s_add_u32 m0, m0, 1024
    s_nop 0
    buffer_load_dwordx4 v197, s[16:19], s40 offen lds
    s_add_u32 m0, m0, 1024
    s_add_u32 s40, s40, 131072
    buffer_load_dwordx4 v196, s[16:19], s41 offen lds
    s_add_u32 m0, m0, 1024
    s_nop 0
    buffer_load_dwordx4 v197, s[16:19], s41 offen lds
    s_add_u32 s41, s41, 131072
    s_add_u32 m0, s34, 65536
    s_nop 0
    buffer_load_dwordx4 v1, s[8:11], s39 offen offset:0 sc1 lds
    buffer_load_dwordx4 v1, s[8:11], s39 offen offset:1024 sc1 lds
    buffer_load_dwordx4 v1, s[8:11], s39 offen offset:2048 sc1 lds
    buffer_load_dwordx4 v1, s[8:11], s39 offen offset:3072 sc1 lds
    s_add_u32 s39, s39, 4096
    s_waitcnt vmcnt(24)
    s_barrier
    s_add_u32 m0, s34, 49152
    s_nop 0
    buffer_load_dwordx4 v196, s[16:19], s40 offen lds
    s_add_u32 m0, m0, 1024
    s_nop 0
    buffer_load_dwordx4 v197, s[16:19], s40 offen lds
    s_add_u32 m0, m0, 1024
    s_add_u32 s40, s40, 131072
    buffer_load_dwordx4 v196, s[16:19], s41 offen lds
    s_add_u32 m0, m0, 1024
    s_nop 0
    buffer_load_dwordx4 v197, s[16:19], s41 offen lds
    s_add_u32 s41, s41, 131072
    s_add_u32 m0, s34, 32768
    s_nop 0
    buffer_load_dwordx4 v1, s[8:11], s39 offen offset:0 sc1 lds
    buffer_load_dwordx4 v1, s[8:11], s39 offen offset:1024 sc1 lds
    buffer_load_dwordx4 v1, s[8:11], s39 offen offset:2048 sc1 lds
    buffer_load_dwordx4 v1, s[8:11], s39 offen offset:3072 sc1 lds
    s_add_u32 s39, s39, 4096
    s_waitcnt vmcnt(24)
    s_barrier
    s_add_u32 m0, s34, 114688
    s_nop 0
    buffer_load_dwordx4 v196, s[16:19], s40 offen lds
    s_add_u32 m0, m0, 1024
    s_nop 0
    buffer_load_dwordx4 v197, s[16:19], s40 offen lds
    s_add_u32 m0, m0, 1024
    s_add_u32 s40, s40, 131072
    buffer_load_dwordx4 v196, s[16:19], s41 offen lds
    s_add_u32 m0, m0, 1024
    s_nop 0
    buffer_load_dwordx4 v197, s[16:19], s41 offen lds
    s_add_u32 s41, s41, 131072
    s_add_u32 m0, s34, 98304
    s_nop 0
    buffer_load_dwordx4 v1, s[8:11], s39 offen offset:0 sc1 lds
    buffer_load_dwordx4 v1, s[8:11], s39 offen offset:1024 sc1 lds
    buffer_load_dwordx4 v1, s[8:11], s39 offen offset:2048 sc1 lds
    buffer_load_dwordx4 v1, s[8:11], s39 offen offset:3072 sc1 lds
    s_add_u32 s39, s39, 4096
    s_waitcnt vmcnt(24)
    s_barrier
    s_add_u32 m0, s34, 147456
    s_nop 0
    buffer_load_dwordx4 v196, s[16:19], s40 offen lds
    s_add_u32 m0, m0, 1024
    s_nop 0
    buffer_load_dwordx4 v197, s[16:19], s40 offen lds
    s_add_u32 m0, m0, 1024
    s_add_u32 s40, s40, 131072
    buffer_load_dwordx4 v196, s[16:19], s41 offen lds
    s_add_u32 m0, m0, 1024
    s_nop 0
    buffer_load_dwordx4 v197, s[16:19], s41 offen lds
    s_add_u32 s41, s41, 131072
    s_add_u32 m0, s34, 131072
    s_nop 0
    buffer_load_dwordx4 v1, s[8:11], s39 offen offset:0 sc1 lds
    buffer_load_dwordx4 v1, s[8:11], s39 offen offset:1024 sc1 lds
    buffer_load_dwordx4 v1, s[8:11], s39 offen offset:2048 sc1 lds
    buffer_load_dwordx4 v1, s[8:11], s39 offen offset:3072 sc1 lds
    s_add_u32 s39, s39, 4096
    s_waitcnt vmcnt(24)
    s_barrier
    s_waitcnt vmcnt(16)
    s_barrier
    s_waitcnt vmcnt(8)
    s_barrier
    s_waitcnt vmcnt(0)
    s_barrier
    s_endpgm
L2_hA:
    s_barrier
    s_cmp_lg_u32 s24, 4
    s_cbranch_scc1 L2A_p1
    s_mov_b64 exec, 1
    buffer_store_dword v204, v203, s[8:11], s95 offen sc1
    s_mov_b64 exec, -1
L2A_p1:
    s_cmp_lg_u32 s24, 5
    s_cbranch_scc1 L2A_qx
    v_cmp_gt_u32 vcc, 0x100, v202
    s_nop 4
    s_cbranch_vccz L2A_cx
    s_mov_b32 s43, 0
L2A_c:
    buffer_load_dword v199, v203, s[80:83], 0 offen sc1
    s_add_u32 s43, s43, 1
    s_waitcnt vmcnt(0)
    v_cmp_gt_u32 vcc, 0x100, v199
    s_cmp_gt_u32 s43, 0x200000
    s_cbranch_scc1 L2A_cx
    s_nop 2
    s_cbranch_vccz L2A_cx
    s_sleep 4
    s_branch L2A_c
L2A_cx:
    s_mov_b32 s43, 0
L2A_q:
    buffer_load_dword v199, v205, s[8:11], s84 offen sc1
    s_add_u32 s43, s43, 1
    s_waitcnt vmcnt(0)
    v_cmp_ne_u32 vcc, 1, v199
    s_cmp_gt_u32 s43, 0x200000
    s_cbranch_scc1 L2A_qx
    s_nop 2
    s_cbranch_vccz L2A_qx
    s_sleep 4
    s_branch L2A_q
L2A_qx:
    s_barrier
    s_add_u32 m0, s34, 0
    s_nop 0
    buffer_load_dwordx4 v1, s[8:11], s35 offen offset:0 sc1 lds
    buffer_load_dwordx4 v1, s[8:11], s35 offen offset:1024 sc1 lds
    buffer_load_dwordx4 v1, s[8:11], s35 offen offset:2048 sc1 lds
    buffer_load_dwordx4 v1, s[8:11], s35 offen offset:3072 sc1 lds
    s_add_u32 s35, s35, 16384
    s_add_u32 m0, s34, 65536
    s_nop 0
    buffer_load_dwordx4 v1, s[8:11], s36 offen offset:0 sc1 lds
    buffer_load_dwordx4 v1, s[8:11], s36 offen offset:1024 sc1 lds
    buffer_load_dwordx4 v1, s[8:11], s36 offen offset:2048 sc1 lds
    buffer_load_dwordx4 v1, s[8:11], s36 offen offset:3072 sc1 lds
    s_add_u32 s36, s36, 16384
    s_waitcnt vmcnt(0)
    s_barrier
    s_add_u32 m0, s34, 16384
    s_nop 0
    buffer_load_dwordx4 v1, s[8:11], s35 offen offset:0 sc1 lds
    buffer_load_dwordx4 v1, s[8:11], s35 offen offset:1024 sc1 lds
    buffer_load_dwordx4 v1, s[8:11], s35 offen offset:2048 sc1 lds
    buffer_load_dwordx4 v1, s[8:11], s35 offen offset:3072 sc1 lds
    s_add_u32 s35, s35, 16384
    s_add_u32 m0, s34, 81920
    s_nop 0
    buffer_load_dwordx4 v1, s[8:11], s36 offen offset:0 sc1 lds
    buffer_load_dwordx4 v1, s[8:11], s36 offen offset:1024 sc1 lds
    buffer_load_dwordx4 v1, s[8:11], s36 offen offset:2048 sc1 lds
    buffer_load_dwordx4 v1, s[8:11], s36 offen offset:3072 sc1 lds
    s_add_u32 s36, s36, 16384
    s_add_u32 m0, s34, 32768
    s_nop 0
    buffer_load_dwordx4 v1, s[8:11], s35 offen offset:0 sc1 lds
    buffer_load_dwordx4 v1, s[8:11], s35 offen offset:1024 sc1 lds
    buffer_load_dwordx4 v1, s[8:11], s35 offen offset:2048 sc1 lds
    buffer_load_dwordx4 v1, s[8:11], s35 offen offset:3072 sc1 lds
    s_add_u32 s35, s35, 16384
    s_add_u32 m0, s34, 98304
    s_nop 0
    buffer_load_dwordx4 v1, s[8:11], s36 offen offset:0 sc1 lds
    buffer_load_dwordx4 v1, s[8:11], s36 offen offset:1024 sc1 lds
    buffer_load_dwordx4 v1, s[8:11], s36 offen offset:2048 sc1 lds
    buffer_load_dwordx4 v1, s[8:11], s36 offen offset:3072 sc1 lds
    s_add_u32 s36, s36, 16384
    v_mov_b32 v4, 0xdddddddd
    v_bfe_u32 v5, v0, 2, 1
    v_cmp_eq_u32 vcc, 0, v5
    v_mov_b32 v6, 0x3f803f80
    s_nop 0
    v_cndmask_b32 v8, 0, v6, vcc
    v_cndmask_b32 v9, 0, v6, vcc
    v_cndmask_b32 v10, v6, 0, vcc
    v_cndmask_b32 v11, v6, 0, vcc
    s_add_u32 s28, s27, 4194304
    s_add_u32 s29, s28, 8388608
    s_add_u32 s30, s28, 16777216
    s_cmp_eq_u32 s25, 0
    s_cselect_b32 s32, 0, 2048
    s_cselect_b64 s[44:45], 0, -1
    s_sub_u32 s31, s29, s32
    s_sub_u32 s32, s30, s32
    s_add_u32 s37, s37, 4194304
    s_add_u32 s38, s37, 0x10000
    v_lshrrev_b32 v5, 3, v0
    v_lshlrev_b32 v5, 11, v5
    v_and_b32 v6, 7, v0
    v_lshl_add_u32 v2, v6, 7, v5
    v_cmp_gt_u32 vcc, 32, v0
    v_mov_b32 v5, 0x7fffff00
    s_and_b32 s47, s21, 15
    s_lshl_b32 s47, s47, 17
    v_cndmask_b32 v2, v5, v2, vcc
    s_lshl_b32 s46, s34, 3
    s_add_u32 s47, s47, s46
    s_and_b32 s46, s20, 1
    s_lshl_b32 s46, s46, 10
    s_add_u32 s47, s47, s46
    s_lshr_b32 s85, s22, 1
    s_lshl_b32 s85, s85, 5
    s_lshr_b32 s43, s25, 1
    s_add_u32 s85, s85, s43
    s_add_u32 s85, s85, 1407
    s_lshl_b32 s85, s85, 5
    s_add_u32 s85, s85, 33554432
    v_and_b32 v207, 1, v0
    v_and_b32 v206, 1, s44
    v_xor_b32 v206, 1, v206
    v_or_b32 v207, v207, v206
    v_lshlrev_b32 v207, 5, v207
    v_mov_b32 v6, 0xf149f2ca
    v_mov_b32 v92, 0
    v_mov_b32 v93, 0
    v_mov_b32 v94, 0
    v_mov_b32 v95, 0
    v_mov_b32 v96, 0
    v_mov_b32 v97, 0
    v_mov_b32 v98, 0
    v_mov_b32 v99, 0
    v_mov_b32 v100, 0
    v_mov_b32 v101, 0
    v_mov_b32 v102, 0
    v_mov_b32 v103, 0
    v_mov_b32 v104, 0
    v_mov_b32 v105, 0
    v_mov_b32 v106, 0
    v_mov_b32 v107, 0
    v_mov_b32 v108, 0
    v_mov_b32 v109, 0
    v_mov_b32 v110, 0
    v_mov_b32 v111, 0
    s_mov_b32 s48, 0x5555
    s_mov_b32 s49, 0x55550000
    v_cndmask_b32 v12, v6, 0, s[48:49]
    s_mov_b32 s50, 0xaaaa
    s_mov_b32 s51, 0xaaaa0000
    v_cndmask_b32 v13, v6, 0, s[50:51]
    s_mov_b32 s52, 0x15554
    s_mov_b32 s53, 0x55540000
    v_cndmask_b32 v14, v6, 0, s[52:53]
    s_mov_b32 s54, 0x2aaa8
    s_mov_b32 s55, 0xaaa80000
    v_cndmask_b32 v15, v6, 0, s[54:55]
    s_mov_b32 s48, 0x55550
    s_mov_b32 s49, 0x55500000
    v_cndmask_b32 v16, v6, 0, s[48:49]
    s_mov_b32 s50, 0xaaaa0
    s_mov_b32 s51, 0xaaa00000
    v_cndmask_b32 v17, v6, 0, s[50:51]
    s_mov_b32 s52, 0x155540
    s_mov_b32 s53, 0x55400000
    v_cndmask_b32 v18, v6, 0, s[52:53]
    s_mov_b32 s54, 0x2aaa80
    s_mov_b32 s55, 0xaa800000
    v_cndmask_b32 v19, v6, 0, s[54:55]
    s_mov_b32 s48, 0x555500
    s_mov_b32 s49, 0x55000000
    v_cndmask_b32 v20, v6, 0, s[48:49]
    s_mov_b32 s50, 0xaaaa00
    s_mov_b32 s51, 0xaa000000
    v_cndmask_b32 v21, v6, 0, s[50:51]
    s_mov_b32 s52, 0x1555400
    s_mov_b32 s53, 0x54000000
    v_cndmask_b32 v22, v6, 0, s[52:53]
    s_mov_b32 s54, 0x2aaa800
    s_mov_b32 s55, 0xa8000000
    v_cndmask_b32 v23, v6, 0, s[54:55]
    s_mov_b32 s48, 0x5555000
    s_mov_b32 s49, 0x50000000
    v_cndmask_b32 v24, v6, 0, s[48:49]
    s_mov_b32 s50, 0xaaaa000
    s_mov_b32 s51, 0xa0000000
    v_cndmask_b32 v25, v6, 0, s[50:51]
    s_mov_b32 s52, 0x15554000
    s_mov_b32 s53, 0x40000000
    v_cndmask_b32 v26, v6, 0, s[52:53]
    s_mov_b32 s54, 0x2aaa8000
    s_mov_b32 s55, 0x80000000
    v_cndmask_b32 v27, v6, 0, s[54:55]
    s_waitcnt vmcnt(8)
    s_barrier
    s_add_u32 m0, s34, 49152
    s_nop 0
    buffer_load_dwordx4 v1, s[8:11], s35 offen offset:0 sc1 lds
    buffer_load_dwordx4 v1, s[8:11], s35 offen offset:1024 sc1 lds
    buffer_load_dwordx4 v1, s[8:11], s35 offen offset:2048 sc1 lds
    buffer_load_dwordx4 v1, s[8:11], s35 offen offset:3072 sc1 lds
    s_add_u32 s35, s35, 16384
    s_add_u32 m0, s34, 114688
    s_nop 0
    buffer_load_dwordx4 v1, s[8:11], s36 offen offset:0 sc1 lds
    buffer_load_dwordx4 v1, s[8:11], s36 offen offset:1024 sc1 lds
    buffer_load_dwordx4 v1, s[8:11], s36 offen offset:2048 sc1 lds
    buffer_load_dwordx4 v1, s[8:11], s36 offen offset:3072 sc1 lds
    s_add_u32 s36, s36, 16384
    v_mov_b32 v6, 0xf149f2ca
    v_mov_b32 v112, 0
    v_mov_b32 v113, 0
    v_mov_b32 v114, 0
    v_mov_b32 v115, 0
    v_mov_b32 v116, 0
    v_mov_b32 v117, 0
    v_mov_b32 v118, 0
    v_mov_b32 v119, 0
    v_mov_b32 v120, 0
    v_mov_b32 v121, 0
    v_mov_b32 v122, 0
    v_mov_b32 v123, 0
    v_mov_b32 v124, 0
    v_mov_b32 v125, 0
    v_mov_b32 v126, 0
    v_mov_b32 v127, 0
    v_mov_b32 v128, 0
    v_mov_b32 v129, 0
    v_mov_b32 v130, 0
    v_mov_b32 v131, 0
    s_mov_b32 s48, 0x0
    s_mov_b32 s49, 0x0
    v_cndmask_b32 v28, v6, 0, s[48:49]
    v_cndmask_b32 v44, v6, v28, s[44:45]
    s_mov_b32 s50, 0x0
    s_mov_b32 s51, 0x0
    v_cndmask_b32 v29, v6, 0, s[50:51]
    v_cndmask_b32 v45, v6, v29, s[44:45]
    s_mov_b32 s52, 0x0
    s_mov_b32 s53, 0x1
    v_cndmask_b32 v30, v6, 0, s[52:53]
    v_cndmask_b32 v46, v6, v30, s[44:45]
    s_mov_b32 s54, 0x0
    s_mov_b32 s55, 0x2
    v_cndmask_b32 v31, v6, 0, s[54:55]
    v_cndmask_b32 v47, v6, v31, s[44:45]
    s_mov_b32 s48, 0x0
    s_mov_b32 s49, 0x5
    v_cndmask_b32 v32, v6, 0, s[48:49]
    v_cndmask_b32 v48, v6, v32, s[44:45]
    s_mov_b32 s50, 0x0
    s_mov_b32 s51, 0xa
    v_cndmask_b32 v33, v6, 0, s[50:51]
    v_cndmask_b32 v49, v6, v33, s[44:45]
    s_mov_b32 s52, 0x0
    s_mov_b32 s53, 0x15
    v_cndmask_b32 v34, v6, 0, s[52:53]
    v_cndmask_b32 v50, v6, v34, s[44:45]
    s_mov_b32 s54, 0x0
    s_mov_b32 s55, 0x2a
    v_cndmask_b32 v35, v6, 0, s[54:55]
    v_cndmask_b32 v51, v6, v35, s[44:45]
    s_mov_b32 s48, 0x0
    s_mov_b32 s49, 0x55
    v_cndmask_b32 v36, v6, 0, s[48:49]
    v_cndmask_b32 v52, v6, v36, s[44:45]
    s_mov_b32 s50, 0x0
    s_mov_b32 s51, 0xaa
    v_cndmask_b32 v37, v6, 0, s[50:51]
    v_cndmask_b32 v53, v6, v37, s[44:45]
    s_mov_b32 s52, 0x0
    s_mov_b32 s53, 0x155
    v_cndmask_b32 v38, v6, 0, s[52:53]
    v_cndmask_b32 v54, v6, v38, s[44:45]
    s_mov_b32 s54, 0x0
    s_mov_b32 s55, 0x2aa
    v_cndmask_b32 v39, v6, 0, s[54:55]
    v_cndmask_b32 v55, v6, v39, s[44:45]
    s_mov_b32 s48, 0x0
    s_mov_b32 s49, 0x555
    v_cndmask_b32 v40, v6, 0, s[48:49]
    v_cndmask_b32 v56, v6, v40, s[44:45]
    s_mov_b32 s50, 0x0
    s_mov_b32 s51, 0xaaa
    v_cndmask_b32 v41, v6, 0, s[50:51]
    v_cndmask_b32 v57, v6, v41, s[44:45]
    s_mov_b32 s52, 0x0
    s_mov_b32 s53, 0x1555
    v_cndmask_b32 v42, v6, 0, s[52:53]
    v_cndmask_b32 v58, v6, v42, s[44:45]
    s_mov_b32 s54, 0x0
    s_mov_b32 s55, 0x2aaa
    v_cndmask_b32 v43, v6, 0, s[54:55]
    v_cndmask_b32 v59, v6, v43, s[44:45]
    v_lshrrev_b32 v5, 4, v0
    v_and_b32 v199, 15, v0
    v_lshlrev_b32 v196, 1, v5
    v_xor_b32 v199, v199, v196
    v_lshlrev_b32 v199, 4, v199
    v_lshl_add_u32 v196, v5, 11, v199
    v_xor_b32 v197, 128, v196
    v_add_u32 v197, 8192, v197
    v_and_b32 v198, 31, v0
    v_lshlrev_b32 v198, 5, v198
    s_lshl_b32 s39, s60, 22
    s_lshl_b32 s40, s61, 18
    s_add_u32 s39, s39, s40
    s_lshl_b32 s40, s34, 4
    s_add_u32 s39, s39, s40
    s_add_u32 s39, s39, 25165824
    s_lshl_b32 s40, s34, 3
    s_lshl_b32 s41, s62, 8
    s_add_u32 s40, s40, s41
    s_add_u32 s41, s40, 16384
    s_lshl_b32 s42, s61, 1
    s_lshr_b32 s43, s34, 13
    s_add_u32 s42, s42, s43
    s_add_u32 s42, s42, 8
    s_lshr_b32 s43, s61, 1
    s_cmp_eq_u32 s60, 0
    s_cselect_b32 s42, s43, s42
    s_lshl_b32 s42, s42, 10
    s_add_u32 s42, s42, 33554432
    s_lshl_b32 s89, s25, 4
    s_add_u32 s89, s89, s22
    s_add_u32 s89, s89, 256
    s_lshl_b32 s89, s89, 5
    s_add_u32 s89, s89, 33554432
    s_waitcnt vmcnt(8)
    s_barrier
    s_add_u32 m0, s34, 0
    s_nop 0
    buffer_load_dwordx4 v1, s[8:11], s35 offen offset:0 sc1 lds
    buffer_load_dwordx4 v1, s[8:11], s35 offen offset:1024 sc1 lds
    buffer_load_dwordx4 v1, s[8:11], s35 offen offset:2048 sc1 lds
    buffer_load_dwordx4 v1, s[8:11], s35 offen offset:3072 sc1 lds
    s_add_u32 s35, s35, 16384
    s_add_u32 m0, s34, 65536
    s_nop 0
    buffer_load_dwordx4 v1, s[8:11], s36 offen offset:0 sc1 lds
    buffer_load_dwordx4 v1, s[8:11], s36 offen offset:1024 sc1 lds
    buffer_load_dwordx4 v1, s[8:11], s36 offen offset:2048 sc1 lds
    buffer_load_dwordx4 v1, s[8:11], s36 offen offset:3072 sc1 lds
    s_add_u32 s36, s36, 16384
    s_mov_b32 s43, 0
L2A_b:
    buffer_load_dword v199, v207, s[8:11], s85 offen sc1
    s_add_u32 s43, s43, 1
    s_waitcnt vmcnt(0)
    v_cmp_ne_u32 vcc, 1, v199
    s_cmp_gt_u32 s43, 0x200000
    s_cbranch_scc1 L2A_bx
    s_nop 2
    s_cbranch_vccz L2A_bx
    s_sleep 4
    s_branch L2A_b
L2A_bx:
    buffer_load_dwordx4 v[132:135], v1, s[8:11], s28 offen offset:0 sc1
    buffer_load_dwordx4 v[136:139], v1, s[8:11], s28 offen offset:1024 sc1
    buffer_load_dwordx4 v[140:143], v1, s[8:11], s28 offen offset:2048 sc1
    buffer_load_dwordx4 v[144:147], v1, s[8:11], s28 offen offset:3072 sc1
    buffer_load_dwordx4 v[148:151], v7, s[8:11], s31 offen offset:0 sc1
    buffer_load_dwordx4 v[152:155], v7, s[8:11], s31 offen offset:1024 sc1
    buffer_load_dwordx4 v[156:159], v7, s[8:11], s29 offen offset:0 sc1
    buffer_load_dwordx4 v[160:163], v7, s[8:11], s29 offen offset:1024 sc1
    buffer_load_dwordx4 v[164:167], v7, s[8:11], s29 offen offset:2048 sc1
    buffer_load_dwordx4 v[168:171], v7, s[8:11], s29 offen offset:3072 sc1
    buffer_load_dwordx4 v[172:175], v1, s[8:11], s32 offen offset:0 sc1
    buffer_load_dwordx4 v[176:179], v1, s[8:11], s32 offen offset:1024 sc1
    buffer_load_dwordx4 v[180:183], v1, s[8:11], s30 offen offset:0 sc1
    buffer_load_dwordx4 v[184:187], v1, s[8:11], s30 offen offset:1024 sc1
    buffer_load_dwordx4 v[188:191], v1, s[8:11], s30 offen offset:2048 sc1
    buffer_load_dwordx4 v[192:195], v1, s[8:11], s30 offen offset:3072 sc1
    buffer_load_dword v3, v2, s[16:19], s47 offen
    s_add_u32 s47, s47, 8192
    s_barrier
    s_add_u32 m0, s34, 16384
    s_nop 0
    buffer_load_dwordx4 v1, s[8:11], s35 offen offset:0 sc1 lds
    buffer_load_dwordx4 v1, s[8:11], s35 offen offset:1024 sc1 lds
    buffer_load_dwordx4 v1, s[8:11], s35 offen offset:2048 sc1 lds
    buffer_load_dwordx4 v1, s[8:11], s35 offen offset:3072 sc1 lds
    s_add_u32 s35, s35, 16384
    s_add_u32 m0, s34, 81920
    s_nop 0
    buffer_load_dwordx4 v1, s[8:11], s36 offen offset:0 sc1 lds
    buffer_load_dwordx4 v1, s[8:11], s36 offen offset:1024 sc1 lds
    buffer_load_dwordx4 v1, s[8:11], s36 offen offset:2048 sc1 lds
    buffer_load_dwordx4 v1, s[8:11], s36 offen offset:3072 sc1 lds
    s_add_u32 s36, s36, 16384
    s_waitcnt vmcnt(9)
    buffer_load_dword v3, v2, s[16:19], s47 offen
    s_add_u32 s47, s47, 8192
    v_mfma_f32_32x32x16_bf16 v[60:75], v[156:159], v[132:135], v[12:27]
    v_mfma_f32_32x32x16_bf16 v[76:91], v[148:151], v[132:135], v[44:59]
    v_mfma_f32_32x32x16_bf16 v[60:75], v[160:163], v[136:139], v[60:75]
    v_mfma_f32_32x32x16_bf16 v[76:91], v[152:155], v[136:139], v[76:91]
    s_nop 10
    v_max3_f32 v5, v60, v61, v62
    v_max3_f32 v6, v63, v64, v65
    v_max3_f32 v5, v5, v66, v67
    v_max3_f32 v6, v6, v68, v69
    v_max3_f32 v5, v5, v70, v71
    v_max3_f32 v6, v6, v72, v73
    v_max3_f32 v5, v5, v74, v75
    v_max3_f32 v6, v6, v76, v77
    v_max3_f32 v5, v5, v78, v79
    v_max3_f32 v6, v6, v80, v81
    v_max3_f32 v5, v5, v82, v83
    v_max3_f32 v6, v6, v84, v85
    v_max3_f32 v5, v5, v86, v87
    v_max3_f32 v6, v6, v88, v89
    v_max3_f32 v5, v5, v90, v91
    v_max_f32 v5, v5, v6
    s_nop 0
    v_mov_b32 v6, v5
    s_nop 1
    v_permlane32_swap_b32 v5, v6
    s_nop 1
    v_max_f32 v5, v5, v6
    v_sub_f32 v60, v60, v5
    v_sub_f32 v61, v61, v5
    v_sub_f32 v62, v62, v5
    v_sub_f32 v63, v63, v5
    v_sub_f32 v64, v64, v5
    v_sub_f32 v65, v65, v5
    v_sub_f32 v66, v66, v5
    v_sub_f32 v67, v67, v5
    v_sub_f32 v68, v68, v5
    v_sub_f32 v69, v69, v5
    v_sub_f32 v70, v70, v5
    v_sub_f32 v71, v71, v5
    v_sub_f32 v72, v72, v5
    v_sub_f32 v73, v73, v5
    v_sub_f32 v74, v74, v5
    v_sub_f32 v75, v75, v5
    v_sub_f32 v76, v76, v5
    v_sub_f32 v77, v77, v5
    v_sub_f32 v78, v78, v5
    v_sub_f32 v79, v79, v5
    v_sub_f32 v80, v80, v5
    v_sub_f32 v81, v81, v5
    v_sub_f32 v82, v82, v5
    v_sub_f32 v83, v83, v5
    v_sub_f32 v84, v84, v5
    v_sub_f32 v85, v85, v5
    v_sub_f32 v86, v86, v5
    v_sub_f32 v87, v87, v5
    v_sub_f32 v88, v88, v5
    v_sub_f32 v89, v89, v5
    v_sub_f32 v90, v90, v5
    v_sub_f32 v91, v91, v5
    v_exp_f32 v60, v60
    v_exp_f32 v61, v61
    v_exp_f32 v62, v62
    v_exp_f32 v63, v63
    v_exp_f32 v64, v64
    v_exp_f32 v65, v65
    v_exp_f32 v66, v66
    v_exp_f32 v67, v67
    v_exp_f32 v68, v68
    v_exp_f32 v69, v69
    v_exp_f32 v70, v70
    v_exp_f32 v71, v71
    v_exp_f32 v72, v72
    v_exp_f32 v73, v73
    v_exp_f32 v74, v74
    v_exp_f32 v75, v75
    v_exp_f32 v76, v76
    v_exp_f32 v77, v77
    v_exp_f32 v78, v78
    v_exp_f32 v79, v79
    v_exp_f32 v80, v80
    v_exp_f32 v81, v81
    v_exp_f32 v82, v82
    v_exp_f32 v83, v83
    v_exp_f32 v84, v84
    v_exp_f32 v85, v85
    v_exp_f32 v86, v86
    v_exp_f32 v87, v87
    v_exp_f32 v88, v88
    s_barrier
    s_add_u32 m0, s34, 32768
    s_nop 0
    buffer_load_dwordx4 v1, s[8:11], s35 offen offset:0 sc1 lds
    buffer_load_dwordx4 v1, s[8:11], s35 offen offset:1024 sc1 lds
    buffer_load_dwordx4 v1, s[8:11], s35 offen offset:2048 sc1 lds
    buffer_load_dwordx4 v1, s[8:11], s35 offen offset:3072 sc1 lds
    s_add_u32 s35, s35, 16384
    s_add_u32 m0, s34, 98304
    s_nop 0
    buffer_load_dwordx4 v1, s[8:11], s36 offen offset:0 sc1 lds
    buffer_load_dwordx4 v1, s[8:11], s36 offen offset:1024 sc1 lds
    buffer_load_dwordx4 v1, s[8:11], s36 offen offset:2048 sc1 lds
    buffer_load_dwordx4 v1, s[8:11], s36 offen offset:3072 sc1 lds
    s_add_u32 s36, s36, 16384
    buffer_load_dword v3, v2, s[16:19], s47 offen
    s_add_u32 s47, s47, 8192
    v_exp_f32 v89, v89
    v_exp_f32 v90, v90
    v_exp_f32 v91, v91
    s_nop 1
    v_smfmac_f32_32x32x32_bf16 v[92:107], v[180:183], v[60:67], v4
    v_smfmac_f32_16x16x64_bf16 v[108:111], v[8:11], v[60:67], v4
    v_smfmac_f32_32x32x32_bf16 v[92:107], v[184:187], v[68:75], v4
    v_smfmac_f32_16x16x64_bf16 v[108:111], v[8:11], v[68:75], v4
    v_smfmac_f32_32x32x32_bf16 v[92:107], v[172:175], v[76:83], v4
    v_smfmac_f32_16x16x64_bf16 v[108:111], v[8:11], v[76:83], v4
    v_smfmac_f32_16x16x64_bf16 v[108:111], v[8:11], v[84:91], v4
    v_smfmac_f32_32x32x32_bf16 v[92:107], v[176:179], v[84:91], v4
    s_nop 12
    v_rcp_f32 v6, v108
    s_nop 0
    v_mul_f32 v92, v92, v6
    v_mul_f32 v93, v93, v6
    v_mul_f32 v94, v94, v6
    v_mul_f32 v95, v95, v6
    v_mul_f32 v96, v96, v6
    v_mul_f32 v97, v97, v6
    v_mul_f32 v98, v98, v6
    v_mul_f32 v99, v99, v6
    v_mul_f32 v100, v100, v6
    v_mul_f32 v101, v101, v6
    v_mul_f32 v102, v102, v6
    v_mul_f32 v103, v103, v6
    v_mul_f32 v104, v104, v6
    v_mul_f32 v105, v105, v6
    v_mul_f32 v106, v106, v6
    v_mul_f32 v107, v107, v6
    v_cvt_pk_bf16_f32 v132, v92, v93
    v_cvt_pk_bf16_f32 v133, v94, v95
    v_cvt_pk_bf16_f32 v134, v96, v97
    v_cvt_pk_bf16_f32 v135, v98, v99
    v_cvt_pk_bf16_f32 v136, v100, v101
    v_cvt_pk_bf16_f32 v137, v102, v103
    v_cvt_pk_bf16_f32 v138, v104, v105
    v_cvt_pk_bf16_f32 v139, v106, v107
    buffer_store_dwordx4 v[132:135], v1, s[8:11], s37 offen sc1
    buffer_store_dwordx4 v[136:139], v1, s[8:11], s37 offen offset:1024 sc1
    v_mfma_f32_32x32x16_bf16 v[60:75], v[164:167], v[140:143], v[12:27]
    v_mfma_f32_32x32x16_bf16 v[76:91], v[156:159], v[140:143], v[28:43]
    v_mfma_f32_32x32x16_bf16 v[60:75], v[168:171], v[144:147], v[60:75]
    v_mfma_f32_32x32x16_bf16 v[76:91], v[160:163], v[144:147], v[76:91]
    s_nop 10
    v_max3_f32 v5, v60, v61, v62
    v_max3_f32 v6, v63, v64, v65
    v_max3_f32 v5, v5, v66, v67
    v_max3_f32 v6, v6, v68, v69
    v_max3_f32 v5, v5, v70, v71
    v_max3_f32 v6, v6, v72, v73
    v_max3_f32 v5, v5, v74, v75
    v_max3_f32 v6, v6, v76, v77
    v_max3_f32 v5, v5, v78, v79
    v_max3_f32 v6, v6, v80, v81
    v_max3_f32 v5, v5, v82, v83
    v_max3_f32 v6, v6, v84, v85
    v_max3_f32 v5, v5, v86, v87
    v_max3_f32 v6, v6, v88, v89
    v_max3_f32 v5, v5, v90, v91
    v_max_f32 v5, v5, v6
    s_nop 0
    v_mov_b32 v6, v5
    s_nop 1
    v_permlane32_swap_b32 v5, v6
    s_nop 1
    v_max_f32 v5, v5, v6
    v_sub_f32 v60, v60, v5
    v_sub_f32 v61, v61, v5
    v_sub_f32 v62, v62, v5
    v_sub_f32 v63, v63, v5
    v_sub_f32 v64, v64, v5
    v_sub_f32 v65, v65, v5
    v_sub_f32 v66, v66, v5
    v_sub_f32 v67, v67, v5
    v_sub_f32 v68, v68, v5
    v_sub_f32 v69, v69, v5
    v_sub_f32 v70, v70, v5
    v_sub_f32 v71, v71, v5
    v_sub_f32 v72, v72, v5
    v_sub_f32 v73, v73, v5
    v_sub_f32 v74, v74, v5
    v_sub_f32 v75, v75, v5
    v_sub_f32 v76, v76, v5
    v_sub_f32 v77, v77, v5
    v_sub_f32 v78, v78, v5
    v_sub_f32 v79, v79, v5
    v_sub_f32 v80, v80, v5
    v_sub_f32 v81, v81, v5
    v_sub_f32 v82, v82, v5
    v_sub_f32 v83, v83, v5
    v_sub_f32 v84, v84, v5
    v_sub_f32 v85, v85, v5
    v_sub_f32 v86, v86, v5
    s_waitcnt vmcnt(12)
    s_barrier
    s_add_u32 m0, s34, 49152
    s_nop 0
    buffer_load_dwordx4 v1, s[8:11], s35 offen offset:0 sc1 lds
    buffer_load_dwordx4 v1, s[8:11], s35 offen offset:1024 sc1 lds
    buffer_load_dwordx4 v1, s[8:11], s35 offen offset:2048 sc1 lds
    buffer_load_dwordx4 v1, s[8:11], s35 offen offset:3072 sc1 lds
    s_add_u32 s35, s35, 16384
    s_add_u32 m0, s34, 114688
    s_nop 0
    buffer_load_dwordx4 v1, s[8:11], s36 offen offset:0 sc1 lds
    buffer_load_dwordx4 v1, s[8:11], s36 offen offset:1024 sc1 lds
    buffer_load_dwordx4 v1, s[8:11], s36 offen offset:2048 sc1 lds
    buffer_load_dwordx4 v1, s[8:11], s36 offen offset:3072 sc1 lds
    s_add_u32 s36, s36, 16384
    buffer_load_dword v3, v2, s[16:19], s47 offen
    s_add_u32 s47, s47, 8192
    s_mov_b32 s12, s58
    s_mov_b32 s13, s59
    s_mov_b32 s14, 0x800000
    s_mov_b32 s15, 0x00020000
    v_lshlrev_b32 v206, 21, v0
    buffer_load_dword v206, v206, s[12:15], 0 offen
    v_sub_f32 v87, v87, v5
    v_sub_f32 v88, v88, v5
    v_sub_f32 v89, v89, v5
    v_sub_f32 v90, v90, v5
    v_sub_f32 v91, v91, v5
    v_exp_f32 v60, v60
    v_exp_f32 v61, v61
    v_exp_f32 v62, v62
    v_exp_f32 v63, v63
    v_exp_f32 v64, v64
    v_exp_f32 v65, v65
    v_exp_f32 v66, v66
    v_exp_f32 v67, v67
    v_exp_f32 v68, v68
    v_exp_f32 v69, v69
    v_exp_f32 v70, v70
    v_exp_f32 v71, v71
    v_exp_f32 v72, v72
    v_exp_f32 v73, v73
    v_exp_f32 v74, v74
    v_exp_f32 v75, v75
    v_exp_f32 v76, v76
    v_exp_f32 v77, v77
    v_exp_f32 v78, v78
    v_exp_f32 v79, v79
    v_exp_f32 v80, v80
    v_exp_f32 v81, v81
    v_exp_f32 v82, v82
    v_exp_f32 v83, v83
    v_exp_f32 v84, v84
    v_exp_f32 v85, v85
    v_exp_f32 v86, v86
    v_exp_f32 v87, v87
    v_exp_f32 v88, v88
    v_exp_f32 v89, v89
    v_exp_f32 v90, v90
    v_exp_f32 v91, v91
    s_nop 1
    v_smfmac_f32_32x32x32_bf16 v[112:127], v[188:191], v[60:67], v4
    v_smfmac_f32_16x16x64_bf16 v[128:131], v[8:11], v[60:67], v4
    v_smfmac_f32_32x32x32_bf16 v[112:127], v[192:195], v[68:75], v4
    v_smfmac_f32_16x16x64_bf16 v[128:131], v[8:11], v[68:75], v4
    v_smfmac_f32_32x32x32_bf16 v[112:127], v[180:183], v[76:83], v4
    v_smfmac_f32_16x16x64_bf16 v[128:131], v[8:11], v[76:83], v4
    v_smfmac_f32_16x16x64_bf16 v[128:131], v[8:11], v[84:91], v4
    v_smfmac_f32_32x32x32_bf16 v[112:127], v[184:187], v[84:91], v4
    s_nop 12
    v_rcp_f32 v6, v128
    s_nop 0
    v_mul_f32 v112, v112, v6
    v_mul_f32 v113, v113, v6
    v_mul_f32 v114, v114, v6
    v_mul_f32 v115, v115, v6
    v_mul_f32 v116, v116, v6
    v_mul_f32 v117, v117, v6
    v_mul_f32 v118, v118, v6
    v_mul_f32 v119, v119, v6
    v_mul_f32 v120, v120, v6
    v_mul_f32 v121, v121, v6
    v_mul_f32 v122, v122, v6
    v_mul_f32 v123, v123, v6
    v_mul_f32 v124, v124, v6
    v_mul_f32 v125, v125, v6
    v_mul_f32 v126, v126, v6
    v_mul_f32 v127, v127, v6
    v_cvt_pk_bf16_f32 v140, v112, v113
    v_cvt_pk_bf16_f32 v141, v114, v115
    v_cvt_pk_bf16_f32 v142, v116, v117
    v_cvt_pk_bf16_f32 v143, v118, v119
    v_cvt_pk_bf16_f32 v144, v120, v121
    v_cvt_pk_bf16_f32 v145, v122, v123
    v_cvt_pk_bf16_f32 v146, v124, v125
    v_cvt_pk_bf16_f32 v147, v126, v127
    buffer_store_dwordx4 v[140:143], v1, s[8:11], s38 offen sc1
    buffer_store_dwordx4 v[144:147], v1, s[8:11], s38 offen offset:1024 sc1
    s_waitcnt vmcnt(15)
    s_barrier
    s_waitcnt vmcnt(0)
    s_mov_b64 exec, 1
    buffer_store_dword v204, v203, s[8:11], s89 offen sc1
    s_mov_b64 exec, -1
    s_add_u32 m0, s34, 147456
    s_nop 0
    buffer_load_dwordx4 v196, s[16:19], s40 offen lds
    s_add_u32 m0, m0, 1024
    s_nop 0
    buffer_load_dwordx4 v197, s[16:19], s40 offen lds
    s_add_u32 m0, m0, 1024
    s_add_u32 s40, s40, 131072
    buffer_load_dwordx4 v196, s[16:19], s41 offen lds
    s_add_u32 m0, m0, 1024
    s_nop 0
    buffer_load_dwordx4 v197, s[16:19], s41 offen lds
    s_add_u32 s41, s41, 131072
    s_add_u32 m0, s34, 16384
    s_nop 0
    buffer_load_dwordx4 v196, s[16:19], s40 offen lds
    s_add_u32 m0, m0, 1024
    s_nop 0
    buffer_load_dwordx4 v197, s[16:19], s40 offen lds
    s_add_u32 m0, m0, 1024
    s_add_u32 s40, s40, 131072
    buffer_load_dwordx4 v196, s[16:19], s41 offen lds
    s_add_u32 m0, m0, 1024
    s_nop 0
    buffer_load_dwordx4 v197, s[16:19], s41 offen lds
    s_add_u32 s41, s41, 131072
    s_waitcnt vmcnt(13)
    s_barrier
    s_add_u32 m0, s34, 81920
    s_nop 0
    buffer_load_dwordx4 v196, s[16:19], s40 offen lds
    s_add_u32 m0, m0, 1024
    s_nop 0
    buffer_load_dwordx4 v197, s[16:19], s40 offen lds
    s_add_u32 m0, m0, 1024
    s_add_u32 s40, s40, 131072
    buffer_load_dwordx4 v196, s[16:19], s41 offen lds
    s_add_u32 m0, m0, 1024
    s_nop 0
    buffer_load_dwordx4 v197, s[16:19], s41 offen lds
    s_add_u32 s41, s41, 131072
    s_barrier
    s_cmp_lg_u32 s24, 4
    s_cbranch_scc1 L2A_p3
    s_mov_b64 exec, 1
    buffer_store_dword v204, v203, s[8:11], s63 offen sc1
    s_mov_b64 exec, -1
L2A_p3:
    s_add_u32 m0, s34, 49152
    s_nop 0
    buffer_load_dwordx4 v196, s[16:19], s40 offen lds
    s_add_u32 m0, m0, 1024
    s_nop 0
    buffer_load_dwordx4 v197, s[16:19], s40 offen lds
    s_add_u32 m0, m0, 1024
    s_add_u32 s40, s40, 131072
    buffer_load_dwordx4 v196, s[16:19], s41 offen lds
    s_add_u32 m0, m0, 1024
    s_nop 0
    buffer_load_dwordx4 v197, s[16:19], s41 offen lds
    s_add_u32 s41, s41, 131072
    s_add_u32 m0, s34, 114688
    s_nop 0
    buffer_load_dwordx4 v196, s[16:19], s40 offen lds
    s_add_u32 m0, m0, 1024
    s_nop 0
    buffer_load_dwordx4 v197, s[16:19], s40 offen lds
    s_add_u32 m0, m0, 1024
    s_add_u32 s40, s40, 131072
    buffer_load_dwordx4 v196, s[16:19], s41 offen lds
    s_add_u32 m0, m0, 1024
    s_nop 0
    buffer_load_dwordx4 v197, s[16:19], s41 offen lds
    s_add_u32 s41, s41, 131072
    s_cmp_lg_u32 s24, 5
    s_cbranch_scc1 L2A_ox
    s_mov_b32 s43, 0
L2A_o:
    buffer_load_dword v199, v198, s[8:11], s42 offen sc1
    s_add_u32 s43, s43, 1
    s_waitcnt vmcnt(0)
    v_cmp_ne_u32 vcc, 1, v199
    s_cmp_gt_u32 s43, 0x200000
    s_cbranch_scc1 L2A_ox
    s_nop 2
    s_cbranch_vccz L2A_ox
    s_sleep 4
    s_branch L2A_o
L2A_ox:
    s_barrier
    s_add_u32 m0, s34, 131072
    s_nop 0
    buffer_load_dwordx4 v1, s[8:11], s39 offen offset:0 sc1 lds
    buffer_load_dwordx4 v1, s[8:11], s39 offen offset:1024 sc1 lds
    buffer_load_dwordx4 v1, s[8:11], s39 offen offset:2048 sc1 lds
    buffer_load_dwordx4 v1, s[8:11], s39 offen offset:3072 sc1 lds
    s_add_u32 s39, s39, 4096
    s_add_u32 m0, s34, 0
    s_nop 0
    buffer_load_dwordx4 v1, s[8:11], s39 offen offset:0 sc1 lds
    buffer_load_dwordx4 v1, s[8:11], s39 offen offset:1024 sc1 lds
    buffer_load_dwordx4 v1, s[8:11], s39 offen offset:2048 sc1 lds
    buffer_load_dwordx4 v1, s[8:11], s39 offen offset:3072 sc1 lds
    s_add_u32 s39, s39, 4096
    s_waitcnt vmcnt(4)
    s_barrier
    s_add_u32 m0, s34, 65536
    s_nop 0
    buffer_load_dwordx4 v1, s[8:11], s39 offen offset:0 sc1 lds
    buffer_load_dwordx4 v1, s[8:11], s39 offen offset:1024 sc1 lds
    buffer_load_dwordx4 v1, s[8:11], s39 offen offset:2048 sc1 lds
    buffer_load_dwordx4 v1, s[8:11], s39 offen offset:3072 sc1 lds
    s_add_u32 s39, s39, 4096
    s_add_u32 m0, s34, 32768
    s_nop 0
    buffer_load_dwordx4 v1, s[8:11], s39 offen offset:0 sc1 lds
    buffer_load_dwordx4 v1, s[8:11], s39 offen offset:1024 sc1 lds
    buffer_load_dwordx4 v1, s[8:11], s39 offen offset:2048 sc1 lds
    buffer_load_dwordx4 v1, s[8:11], s39 offen offset:3072 sc1 lds
    s_add_u32 s39, s39, 4096
    s_add_u32 m0, s34, 98304
    s_nop 0
    buffer_load_dwordx4 v1, s[8:11], s39 offen offset:0 sc1 lds
    buffer_load_dwordx4 v1, s[8:11], s39 offen offset:1024 sc1 lds
    buffer_load_dwordx4 v1, s[8:11], s39 offen offset:2048 sc1 lds
    buffer_load_dwordx4 v1, s[8:11], s39 offen offset:3072 sc1 lds
    s_add_u32 s39, s39, 4096
    s_waitcnt vmcnt(12)
    s_barrier
    s_add_u32 m0, s34, 147456
    s_nop 0
    buffer_load_dwordx4 v196, s[16:19], s40 offen lds
    s_add_u32 m0, m0, 1024
    s_nop 0
    buffer_load_dwordx4 v197, s[16:19], s40 offen lds
    s_add_u32 m0, m0, 1024
    s_add_u32 s40, s40, 131072
    buffer_load_dwordx4 v196, s[16:19], s41 offen lds
    s_add_u32 m0, m0, 1024
    s_nop 0
    buffer_load_dwordx4 v197, s[16:19], s41 offen lds
    s_add_u32 s41, s41, 131072
    s_add_u32 m0, s34, 131072
    s_nop 0
    buffer_load_dwordx4 v1, s[8:11], s39 offen offset:0 sc1 lds
    buffer_load_dwordx4 v1, s[8:11], s39 offen offset:1024 sc1 lds
    buffer_load_dwordx4 v1, s[8:11], s39 offen offset:2048 sc1 lds
    buffer_load_dwordx4 v1, s[8:11], s39 offen offset:3072 sc1 lds
    s_add_u32 s39, s39, 4096
    s_waitcnt vmcnt(16)
    s_barrier
    s_add_u32 m0, s34, 16384
    s_nop 0
    buffer_load_dwordx4 v196, s[16:19], s40 offen lds
    s_add_u32 m0, m0, 1024
    s_nop 0
    buffer_load_dwordx4 v197, s[16:19], s40 offen lds
    s_add_u32 m0, m0, 1024
    s_add_u32 s40, s40, 131072
    buffer_load_dwordx4 v196, s[16:19], s41 offen lds
    s_add_u32 m0, m0, 1024
    s_nop 0
    buffer_load_dwordx4 v197, s[16:19], s41 offen lds
    s_add_u32 s41, s41, 131072
    s_add_u32 m0, s34, 0
    s_nop 0
    buffer_load_dwordx4 v1, s[8:11], s39 offen offset:0 sc1 lds
    buffer_load_dwordx4 v1, s[8:11], s39 offen offset:1024 sc1 lds
    buffer_load_dwordx4 v1, s[8:11], s39 offen offset:2048 sc1 lds
    buffer_load_dwordx4 v1, s[8:11], s39 offen offset:3072 sc1 lds
    s_add_u32 s39, s39, 4096
    s_waitcnt vmcnt(20)
    s_barrier
    s_add_u32 m0, s34, 81920
    s_nop 0
    buffer_load_dwordx4 v196, s[16:19], s40 offen lds
    s_add_u32 m0, m0, 1024
    s_nop 0
    buffer_load_dwordx4 v197, s[16:19], s40 offen lds
    s_add_u32 m0, m0, 1024
    s_add_u32 s40, s40, 131072
    buffer_load_dwordx4 v196, s[16:19], s41 offen lds
    s_add_u32 m0, m0, 1024
    s_nop 0
    buffer_load_dwordx4 v197, s[16:19], s41 offen lds
    s_add_u32 s41, s41, 131072
    s_add_u32 m0, s34, 65536
    s_nop 0
    buffer_load_dwordx4 v1, s[8:11], s39 offen offset:0 sc1 lds
    buffer_load_dwordx4 v1, s[8:11], s39 offen offset:1024 sc1 lds
    buffer_load_dwordx4 v1, s[8:11], s39 offen offset:2048 sc1 lds
    buffer_load_dwordx4 v1, s[8:11], s39 offen offset:3072 sc1 lds
    s_add_u32 s39, s39, 4096
    s_waitcnt vmcnt(24)
    s_barrier
    s_add_u32 m0, s34, 49152
    s_nop 0
    buffer_load_dwordx4 v196, s[16:19], s40 offen lds
    s_add_u32 m0, m0, 1024
    s_nop 0
    buffer_load_dwordx4 v197, s[16:19], s40 offen lds
    s_add_u32 m0, m0, 1024
    s_add_u32 s40, s40, 131072
    buffer_load_dwordx4 v196, s[16:19], s41 offen lds
    s_add_u32 m0, m0, 1024
    s_nop 0
    buffer_load_dwordx4 v197, s[16:19], s41 offen lds
    s_add_u32 s41, s41, 131072
    s_add_u32 m0, s34, 32768
    s_nop 0
    buffer_load_dwordx4 v1, s[8:11], s39 offen offset:0 sc1 lds
    buffer_load_dwordx4 v1, s[8:11], s39 offen offset:1024 sc1 lds
    buffer_load_dwordx4 v1, s[8:11], s39 offen offset:2048 sc1 lds
    buffer_load_dwordx4 v1, s[8:11], s39 offen offset:3072 sc1 lds
    s_add_u32 s39, s39, 4096
    s_waitcnt vmcnt(24)
    s_barrier
    s_add_u32 m0, s34, 114688
    s_nop 0
    buffer_load_dwordx4 v196, s[16:19], s40 offen lds
    s_add_u32 m0, m0, 1024
    s_nop 0
    buffer_load_dwordx4 v197, s[16:19], s40 offen lds
    s_add_u32 m0, m0, 1024
    s_add_u32 s40, s40, 131072
    buffer_load_dwordx4 v196, s[16:19], s41 offen lds
    s_add_u32 m0, m0, 1024
    s_nop 0
    buffer_load_dwordx4 v197, s[16:19], s41 offen lds
    s_add_u32 s41, s41, 131072
    s_add_u32 m0, s34, 98304
    s_nop 0
    buffer_load_dwordx4 v1, s[8:11], s39 offen offset:0 sc1 lds
    buffer_load_dwordx4 v1, s[8:11], s39 offen offset:1024 sc1 lds
    buffer_load_dwordx4 v1, s[8:11], s39 offen offset:2048 sc1 lds
    buffer_load_dwordx4 v1, s[8:11], s39 offen offset:3072 sc1 lds
    s_add_u32 s39, s39, 4096
    s_waitcnt vmcnt(24)
    s_barrier
    s_add_u32 m0, s34, 147456
    s_nop 0
    buffer_load_dwordx4 v196, s[16:19], s40 offen lds
    s_add_u32 m0, m0, 1024
    s_nop 0
    buffer_load_dwordx4 v197, s[16:19], s40 offen lds
    s_add_u32 m0, m0, 1024
    s_add_u32 s40, s40, 131072
    buffer_load_dwordx4 v196, s[16:19], s41 offen lds
    s_add_u32 m0, m0, 1024
    s_nop 0
    buffer_load_dwordx4 v197, s[16:19], s41 offen lds
    s_add_u32 s41, s41, 131072
    s_add_u32 m0, s34, 131072
    s_nop 0
    buffer_load_dwordx4 v1, s[8:11], s39 offen offset:0 sc1 lds
    buffer_load_dwordx4 v1, s[8:11], s39 offen offset:1024 sc1 lds
    buffer_load_dwordx4 v1, s[8:11], s39 offen offset:2048 sc1 lds
    buffer_load_dwordx4 v1, s[8:11], s39 offen offset:3072 sc1 lds
    s_add_u32 s39, s39, 4096
    s_waitcnt vmcnt(24)
    s_barrier
    s_add_u32 m0, s34, 16384
    s_nop 0
    buffer_load_dwordx4 v196, s[16:19], s40 offen lds
    s_add_u32 m0, m0, 1024
    s_nop 0
    buffer_load_dwordx4 v197, s[16:19], s40 offen lds
    s_add_u32 m0, m0, 1024
    s_add_u32 s40, s40, 131072
    buffer_load_dwordx4 v196, s[16:19], s41 offen lds
    s_add_u32 m0, m0, 1024
    s_nop 0
    buffer_load_dwordx4 v197, s[16:19], s41 offen lds
    s_add_u32 s41, s41, 131072
    s_add_u32 m0, s34, 0
    s_nop 0
    buffer_load_dwordx4 v1, s[8:11], s39 offen offset:0 sc1 lds
    buffer_load_dwordx4 v1, s[8:11], s39 offen offset:1024 sc1 lds
    buffer_load_dwordx4 v1, s[8:11], s39 offen offset:2048 sc1 lds
    buffer_load_dwordx4 v1, s[8:11], s39 offen offset:3072 sc1 lds
    s_add_u32 s39, s39, 4096
    s_waitcnt vmcnt(24)
    s_barrier
    s_add_u32 m0, s34, 81920
    s_nop 0
    buffer_load_dwordx4 v196, s[16:19], s40 offen lds
    s_add_u32 m0, m0, 1024
    s_nop 0
    buffer_load_dwordx4 v197, s[16:19], s40 offen lds
    s_add_u32 m0, m0, 1024
    s_add_u32 s40, s40, 131072
    buffer_load_dwordx4 v196, s[16:19], s41 offen lds
    s_add_u32 m0, m0, 1024
    s_nop 0
    buffer_load_dwordx4 v197, s[16:19], s41 offen lds
    s_add_u32 s41, s41, 131072
    s_add_u32 m0, s34, 65536
    s_nop 0
    buffer_load_dwordx4 v1, s[8:11], s39 offen offset:0 sc1 lds
    buffer_load_dwordx4 v1, s[8:11], s39 offen offset:1024 sc1 lds
    buffer_load_dwordx4 v1, s[8:11], s39 offen offset:2048 sc1 lds
    buffer_load_dwordx4 v1, s[8:11], s39 offen offset:3072 sc1 lds
    s_add_u32 s39, s39, 4096
    s_waitcnt vmcnt(24)
    s_barrier
    s_add_u32 m0, s34, 49152
    s_nop 0
    buffer_load_dwordx4 v196, s[16:19], s40 offen lds
    s_add_u32 m0, m0, 1024
    s_nop 0
    buffer_load_dwordx4 v197, s[16:19], s40 offen lds
    s_add_u32 m0, m0, 1024
    s_add_u32 s40, s40, 131072
    buffer_load_dwordx4 v196, s[16:19], s41 offen lds
    s_add_u32 m0, m0, 1024
    s_nop 0
    buffer_load_dwordx4 v197, s[16:19], s41 offen lds
    s_add_u32 s41, s41, 131072
    s_add_u32 m0, s34, 32768
    s_nop 0
    buffer_load_dwordx4 v1, s[8:11], s39 offen offset:0 sc1 lds
    buffer_load_dwordx4 v1, s[8:11], s39 offen offset:1024 sc1 lds
    buffer_load_dwordx4 v1, s[8:11], s39 offen offset:2048 sc1 lds
    buffer_load_dwordx4 v1, s[8:11], s39 offen offset:3072 sc1 lds
    s_add_u32 s39, s39, 4096
    s_waitcnt vmcnt(24)
    s_barrier
    s_add_u32 m0, s34, 114688
    s_nop 0
    buffer_load_dwordx4 v196, s[16:19], s40 offen lds
    s_add_u32 m0, m0, 1024
    s_nop 0
    buffer_load_dwordx4 v197, s[16:19], s40 offen lds
    s_add_u32 m0, m0, 1024
    s_add_u32 s40, s40, 131072
    buffer_load_dwordx4 v196, s[16:19], s41 offen lds
    s_add_u32 m0, m0, 1024
    s_nop 0
    buffer_load_dwordx4 v197, s[16:19], s41 offen lds
    s_add_u32 s41, s41, 131072
    s_add_u32 m0, s34, 98304
    s_nop 0
    buffer_load_dwordx4 v1, s[8:11], s39 offen offset:0 sc1 lds
    buffer_load_dwordx4 v1, s[8:11], s39 offen offset:1024 sc1 lds
    buffer_load_dwordx4 v1, s[8:11], s39 offen offset:2048 sc1 lds
    buffer_load_dwordx4 v1, s[8:11], s39 offen offset:3072 sc1 lds
    s_add_u32 s39, s39, 4096
    s_waitcnt vmcnt(24)
    s_barrier
    s_add_u32 m0, s34, 147456
    s_nop 0
    buffer_load_dwordx4 v196, s[16:19], s40 offen lds
    s_add_u32 m0, m0, 1024
    s_nop 0
    buffer_load_dwordx4 v197, s[16:19], s40 offen lds
    s_add_u32 m0, m0, 1024
    s_add_u32 s40, s40, 131072
    buffer_load_dwordx4 v196, s[16:19], s41 offen lds
    s_add_u32 m0, m0, 1024
    s_nop 0
    buffer_load_dwordx4 v197, s[16:19], s41 offen lds
    s_add_u32 s41, s41, 131072
    s_add_u32 m0, s34, 131072
    s_nop 0
    buffer_load_dwordx4 v1, s[8:11], s39 offen offset:0 sc1 lds
    buffer_load_dwordx4 v1, s[8:11], s39 offen offset:1024 sc1 lds
    buffer_load_dwordx4 v1, s[8:11], s39 offen offset:2048 sc1 lds
    buffer_load_dwordx4 v1, s[8:11], s39 offen offset:3072 sc1 lds
    s_add_u32 s39, s39, 4096
    s_waitcnt vmcnt(24)
    s_barrier
    s_waitcnt vmcnt(16)
    s_barrier
    s_waitcnt vmcnt(8)
    s_barrier
    s_waitcnt vmcnt(0)
    s_barrier
    s_endpgm
L2_slow0:
    s_add_u32 s36, s26, 16777216
    v_mov_b32 v5, 0xff800000
    s_mov_b32 s39, 0
L2_s10:
    s_add_u32 s41, s33, s39
    buffer_load_dwordx4 v[100:103], v7, s[8:11], s41 offen offset:0 sc1
    buffer_load_dwordx4 v[104:107], v7, s[8:11], s41 offen offset:1024 sc1
    s_waitcnt vmcnt(0)
    v_mfma_f32_32x32x16_bf16 v[132:147], v[100:103], v[12:15], 0
    v_mfma_f32_32x32x16_bf16 v[132:147], v[104:107], v[16:19], v[132:147]
    s_nop 15
    v_max3_f32 v5, v5, v132, v133
    v_max3_f32 v5, v5, v134, v135
    v_max3_f32 v5, v5, v136, v137
    v_max3_f32 v5, v5, v138, v139
    v_max3_f32 v5, v5, v140, v141
    v_max3_f32 v5, v5, v142, v143
    v_max3_f32 v5, v5, v144, v145
    v_max3_f32 v5, v5, v146, v147
    s_add_u32 s39, s39, 2048
    s_cmp_lt_u32 s39, 131072
    s_cbranch_scc1 L2_s10
    v_mov_b32 v6, v5
    v_max_f32 v5, v5, v6
    s_nop 0
    v_mov_b32 v6, v5
    s_nop 1
    v_permlane32_swap_b32 v5, v6
    s_nop 1
    v_max_f32 v5, v5, v6
    v_sub_f32 v28, 0, v5
    v_sub_f32 v29, 0, v5
    v_sub_f32 v30, 0, v5
    v_sub_f32 v31, 0, v5
    v_sub_f32 v32, 0, v5
    v_sub_f32 v33, 0, v5
    v_sub_f32 v34, 0, v5
    v_sub_f32 v35, 0, v5
    v_sub_f32 v36, 0, v5
    v_sub_f32 v37, 0, v5
    v_sub_f32 v38, 0, v5
    v_sub_f32 v39, 0, v5
    v_sub_f32 v40, 0, v5
    v_sub_f32 v41, 0, v5
    v_sub_f32 v42, 0, v5
    v_sub_f32 v43, 0, v5
    v_mov_b32 v60, 0
    v_mov_b32 v61, 0
    v_mov_b32 v62, 0
    v_mov_b32 v63, 0
    v_mov_b32 v64, 0
    v_mov_b32 v65, 0
    v_mov_b32 v66, 0
    v_mov_b32 v67, 0
    v_mov_b32 v68, 0
    v_mov_b32 v69, 0
    v_mov_b32 v70, 0
    v_mov_b32 v71, 0
    v_mov_b32 v72, 0
    v_mov_b32 v73, 0
    v_mov_b32 v74, 0
    v_mov_b32 v75, 0
    v_mov_b32 v92, 0
    v_mov_b32 v93, 0
    v_mov_b32 v94, 0
    v_mov_b32 v95, 0
    s_mov_b32 s39, 0
L2_s20:
    s_add_u32 s41, s33, s39
    buffer_load_dwordx4 v[100:103], v7, s[8:11], s41 offen offset:0 sc1
    buffer_load_dwordx4 v[104:107], v7, s[8:11], s41 offen offset:1024 sc1
    s_add_u32 s41, s36, s39
    buffer_load_dwordx4 v[116:119], v1, s[8:11], s41 offen offset:0 sc1
    buffer_load_dwordx4 v[120:123], v1, s[8:11], s41 offen offset:1024 sc1
    s_waitcnt vmcnt(0)
    v_mfma_f32_32x32x16_bf16 v[132:147], v[100:103], v[12:15], v[28:43]
    v_mfma_f32_32x32x16_bf16 v[132:147], v[104:107], v[16:19], v[132:147]
    s_nop 15
    v_exp_f32 v132, v132
    v_exp_f32 v133, v133
    v_exp_f32 v134, v134
    v_exp_f32 v135, v135
    v_exp_f32 v136, v136
    v_exp_f32 v137, v137
    v_exp_f32 v138, v138
    v_exp_f32 v139, v139
    v_exp_f32 v140, v140
    v_exp_f32 v141, v141
    v_exp_f32 v142, v142
    v_exp_f32 v143, v143
    v_exp_f32 v144, v144
    v_exp_f32 v145, v145
    v_exp_f32 v146, v146
    v_exp_f32 v147, v147
    s_nop 1
    v_smfmac_f32_32x32x32_bf16 v[60:75], v[116:119], v[132:139], v4
    v_smfmac_f32_16x16x64_bf16 v[92:95], v[8:11], v[132:139], v4
    v_smfmac_f32_32x32x32_bf16 v[60:75], v[120:123], v[140:147], v4
    v_smfmac_f32_16x16x64_bf16 v[92:95], v[8:11], v[140:147], v4
    s_nop 7
    s_add_u32 s39, s39, 2048
    s_cmp_lt_u32 s39, 131072
    s_cbranch_scc1 L2_s20
    s_nop 15
    s_branch L2_fin0
L2_slow1:
    s_add_u32 s36, s26, 16777216
    v_mov_b32 v5, 0xff800000
    s_mov_b32 s39, 0
L2_s11:
    s_add_u32 s41, s33, s39
    buffer_load_dwordx4 v[100:103], v7, s[8:11], s41 offen offset:0 sc1
    buffer_load_dwordx4 v[104:107], v7, s[8:11], s41 offen offset:1024 sc1
    s_waitcnt vmcnt(0)
    v_mfma_f32_32x32x16_bf16 v[132:147], v[100:103], v[20:23], 0
    v_mfma_f32_32x32x16_bf16 v[132:147], v[104:107], v[24:27], v[132:147]
    s_nop 15
    v_max3_f32 v5, v5, v132, v133
    v_max3_f32 v5, v5, v134, v135
    v_max3_f32 v5, v5, v136, v137
    v_max3_f32 v5, v5, v138, v139
    v_max3_f32 v5, v5, v140, v141
    v_max3_f32 v5, v5, v142, v143
    v_max3_f32 v5, v5, v144, v145
    v_max3_f32 v5, v5, v146, v147
    s_add_u32 s39, s39, 2048
    s_cmp_lt_u32 s39, 131072
    s_cbranch_scc1 L2_s11
    v_mov_b32 v6, v5
    v_max_f32 v5, v5, v6
    s_nop 0
    v_mov_b32 v6, v5
    s_nop 1
    v_permlane32_swap_b32 v5, v6
    s_nop 1
    v_max_f32 v5, v5, v6
    v_sub_f32 v44, 0, v5
    v_sub_f32 v45, 0, v5
    v_sub_f32 v46, 0, v5
    v_sub_f32 v47, 0, v5
    v_sub_f32 v48, 0, v5
    v_sub_f32 v49, 0, v5
    v_sub_f32 v50, 0, v5
    v_sub_f32 v51, 0, v5
    v_sub_f32 v52, 0, v5
    v_sub_f32 v53, 0, v5
    v_sub_f32 v54, 0, v5
    v_sub_f32 v55, 0, v5
    v_sub_f32 v56, 0, v5
    v_sub_f32 v57, 0, v5
    v_sub_f32 v58, 0, v5
    v_sub_f32 v59, 0, v5
    v_mov_b32 v76, 0
    v_mov_b32 v77, 0
    v_mov_b32 v78, 0
    v_mov_b32 v79, 0
    v_mov_b32 v80, 0
    v_mov_b32 v81, 0
    v_mov_b32 v82, 0
    v_mov_b32 v83, 0
    v_mov_b32 v84, 0
    v_mov_b32 v85, 0
    v_mov_b32 v86, 0
    v_mov_b32 v87, 0
    v_mov_b32 v88, 0
    v_mov_b32 v89, 0
    v_mov_b32 v90, 0
    v_mov_b32 v91, 0
    v_mov_b32 v96, 0
    v_mov_b32 v97, 0
    v_mov_b32 v98, 0
    v_mov_b32 v99, 0
    s_mov_b32 s39, 0
L2_s21:
    s_add_u32 s41, s33, s39
    buffer_load_dwordx4 v[100:103], v7, s[8:11], s41 offen offset:0 sc1
    buffer_load_dwordx4 v[104:107], v7, s[8:11], s41 offen offset:1024 sc1
    s_add_u32 s41, s36, s39
    buffer_load_dwordx4 v[116:119], v1, s[8:11], s41 offen offset:0 sc1
    buffer_load_dwordx4 v[120:123], v1, s[8:11], s41 offen offset:1024 sc1
    s_waitcnt vmcnt(0)
    v_mfma_f32_32x32x16_bf16 v[132:147], v[100:103], v[20:23], v[44:59]
    v_mfma_f32_32x32x16_bf16 v[132:147], v[104:107], v[24:27], v[132:147]
    s_nop 15
    v_exp_f32 v132, v132
    v_exp_f32 v133, v133
    v_exp_f32 v134, v134
    v_exp_f32 v135, v135
    v_exp_f32 v136, v136
    v_exp_f32 v137, v137
    v_exp_f32 v138, v138
    v_exp_f32 v139, v139
    v_exp_f32 v140, v140
    v_exp_f32 v141, v141
    v_exp_f32 v142, v142
    v_exp_f32 v143, v143
    v_exp_f32 v144, v144
    v_exp_f32 v145, v145
    v_exp_f32 v146, v146
    v_exp_f32 v147, v147
    s_nop 1
    v_smfmac_f32_32x32x32_bf16 v[76:91], v[116:119], v[132:139], v4
    v_smfmac_f32_16x16x64_bf16 v[96:99], v[8:11], v[132:139], v4
    v_smfmac_f32_32x32x32_bf16 v[76:91], v[120:123], v[140:147], v4
    v_smfmac_f32_16x16x64_bf16 v[96:99], v[8:11], v[140:147], v4
    s_nop 7
    s_add_u32 s39, s39, 2048
    s_cmp_lt_u32 s39, 131072
    s_cbranch_scc1 L2_s21
    s_nop 15
    s_branch L2_fin1
.section .rodata,"a"
.p2align 6
.amdhsa_kernel concat_heads__mha_block__sliding_local_dilated__prompt_kernel
  .amdhsa_next_free_vgpr 256
  .amdhsa_next_free_sgpr 102
  .amdhsa_accum_offset 256
  .amdhsa_group_segment_fixed_size 0
  .amdhsa_kernarg_size 72
  .amdhsa_user_sgpr_count 2
  .amdhsa_user_sgpr_kernarg_segment_ptr 1
  .amdhsa_system_sgpr_workgroup_id_x 1
.end_amdhsa_kernel
```
